```python
import torch

def _softmax(x, axis=-1):
    return torch.softmax(x, dim=axis)
def _gelu(x):
    return torch.nn.functional.gelu(x, approximate="tanh")
def _silu(x):
    return torch.nn.functional.silu(x)
def _sigmoid(x):
    return torch.sigmoid(x)
def _layernorm(x, axis=-1, eps=1e-5):
    m = x.mean(dim=axis, keepdim=True)
    v = x.var(dim=axis, keepdim=True, unbiased=False)
    return (x - m) / torch.sqrt(v + eps)
def _scatter_add(tgt, idx, src, axis=0):
    return tgt.clone().index_add_(axis, idx, src)
def _segment_sum(src, seg, n):
    out = torch.zeros((n,) + src.shape[1:], dtype=src.dtype)
    return out.index_add_(0, seg, src)
def _pad(x, pw):
    flat = tuple(v for pair in reversed(pw) for v in pair)
    return torch.nn.functional.pad(x, flat)

kernel_name = 'concat_heads__spectral_gfnet__softmax_full_mha__prompt'

def setup_inputs():

    _w = (lambda a: (lambda t: t.to(torch.bfloat16) if t.is_floating_point() else t)(torch.as_tensor(a)))
    def _A_setup():
        B, S, D = 1, 2048, 448
        Df = D // 2 + 1
        return {
            "x": _w((lambda *s: torch.randn(*s, dtype=torch.bfloat16) * 0.05)(B, S, D)),
            "w_r": _w((lambda *s: torch.randn(*s, dtype=torch.bfloat16) * 6.4)(S, Df) * 0.02),
            "w_i": _w((lambda *s: torch.randn(*s, dtype=torch.bfloat16) * 6.4)(S, Df) * 0.02),
        }
    _A_in = _A_setup()

    def _B_setup():
        B, S, D = 1, 2048, 448
        return {
            "x": _w((lambda *s: torch.randn(*s, dtype=torch.bfloat16) * 0.2)(B, S, D)),
            "wqkv": _w((lambda *s: torch.randn(*s, dtype=torch.bfloat16) * 0.2)(D, 3 * D)),
            "wo": _w((lambda *s: torch.randn(*s, dtype=torch.bfloat16) * 0.05)(D, D)),
        }
    _B_in = _B_setup()

    return {
        "A_x": _A_in["x"],
        "A_w_r": _A_in["w_r"],
        "A_w_i": _A_in["w_i"],
        "B_x": _B_in["x"],
        "B_wqkv": _B_in["wqkv"],
        "B_wo": _B_in["wo"],
    }

def reference(A_x, A_w_r, A_w_i, B_x, B_wqkv, B_wo):
    def _A_ref(x, w_r, w_i):
        B, S, D = x.shape
        X = (lambda x, axes=(-2,-1): torch.fft.rfft2(x.float(), dim=axes))(x, axes=(-2, -1))
        W = w_r + 1j * w_i
        X = X * W
        y = (lambda x, s, axes=(-2,-1): torch.fft.irfft2(x, s=s, dim=axes).to(torch.bfloat16))(X, (S, D), axes=(-2, -1))
        return y

    def _B_ref(x, wqkv, wo):
        B, S, D = x.shape
        H = 16; Dh = D // H
        qkv = (lambda x, *d: x.permute(*d))((x @ wqkv).reshape(B, S, 3, H, Dh), 2, 0, 3, 1, 4)
        q, k, v = qkv[0], qkv[1], qkv[2]
        scale = Dh ** -0.5
        scores = torch.einsum("bhqd,bhkd->bhqk", q, k) * scale
        p = _softmax(scores, axis=-1)
        o = torch.einsum("bhqk,bhkd->bhqd", p, v)
        return (lambda x, *d: x.permute(*d))(o, 0, 2, 1, 3).reshape(B, S, D) @ wo

    a = _A_ref(A_x, A_w_r, A_w_i)
    b = _B_ref(B_x, B_wqkv, B_wo)
    return torch.concatenate([a, b], axis=-1)
```

```asm
; @launch grid=(256,1,1) block=(512,1,1) lds=163840
.amdgcn_target "amdgcn-amd-amdhsa--gfx950"
.text
.globl concat_heads__spectral_gfnet__softmax_full_mha__prompt_kernel
.p2align 8
.type concat_heads__spectral_gfnet__softmax_full_mha__prompt_kernel,@function
concat_heads__spectral_gfnet__softmax_full_mha__prompt_kernel:
    s_cmp_ge_u32 s2, 256
    s_cbranch_scc1 L_fin
    s_load_dwordx16 s[8:23], s[0:1], 0
    s_load_dwordx2 s[24:25], s[0:1], 64
    v_lshrrev_b32 v1, 6, v0
    s_nop 0
    v_readfirstlane_b32 s3, v1
    v_and_b32 v0, 63, v0
    s_cmp_lg_u32 s3, 3
    s_cbranch_scc1 pf_1
    s_getpc_b64 s[56:57]
pc_2:
    s_lshr_b32 s58, s2, 3
    s_add_u32 s58, s58, s3
    s_and_b32 s58, s58, 3
    s_lshl_b32 s58, s58, 13
    v_lshlrev_b32 v1, 7, v0
    v_add_u32 v1, s58, v1
    v_min_u32 v1, L_fin-pc_2, v1
    global_load_dword v63, v1, s[56:57]
pf_1:
    s_and_b32 s4, s2, 7
    s_lshr_b32 s5, s2, 3
    s_lshl_b32 s6, s4, 1
    s_and_b32 s7, s5, 1
    s_or_b32 s6, s6, s7
    s_lshr_b32 s7, s5, 1
    s_and_b32 s40, s3, 3
    s_cmp_ge_u32 s7, 11
    s_cbranch_scc1 L_a1
    s_and_b32 s26, s4, 1
    s_mul_i32 s26, s26, 6
    s_lshr_b32 s7, s5, 2
    s_add_u32 s7, s7, s26
    s_and_b32 s26, s6, 12
    s_and_b32 s27, s5, 3
    s_or_b32 s26, s26, s27
    s_cmp_lt_u32 s5, 20
    s_cselect_b32 s6, s26, s6
    s_cselect_b32 s7, s7, 5
    s_cmp_lt_u32 s3, 4
    s_cbranch_scc1 L_b1c
    s_setprio 3
    s_add_u32 s26, s6, s7
    s_mul_i32 s27, s26, 37
    s_lshr_b32 s27, s27, 8
    s_mul_i32 s27, s27, 7
    s_sub_u32 s26, s26, s27
    s_mov_b32 s26, 0
    v_lshrrev_b32 v17, 3, v0
    v_and_b32 v14, 7, v0
    v_lshrrev_b32 v15, 4, v0
    v_xor_b32 v14, v14, v15
    v_lshlrev_b32 v14, 4, v14
    v_xor_b32 v16, 64, v14
    v_mul_u32_u24 v17, 896, v17
    v_add_u32 v2, v17, v14
    v_add_u32 v3, v17, v16
    v_add_u32 v3, 6144, v3
    v_add_u32 v4, 12288, v2
    v_add_u32 v5, 12288, v3
    v_and_b32 v14, 15, v0
    v_lshlrev_b32 v16, 2, v15
    v_xor_b32 v14, v14, v16
    v_lshlrev_b32 v14, 4, v14
    v_mul_u32_u24 v15, 2688, v15
    v_add_u32 v6, v14, v15
    v_add_u32 v7, 9728, v6
    v_add_u32 v8, 19456, v6
    v_add_u32 v9, 29184, v6
    s_lshl_b32 s41, s6, 2
    s_add_u32 s47, s41, s40
    s_mul_i32 s41, s47, 28672
    s_mul_i32 s42, s40, 43008
    s_lshl_b32 s43, s7, 8
    s_add_u32 s42, s42, s43
    s_lshl_b32 s44, s40, 12
    s_waitcnt lgkmcnt(0)
    s_mov_b32 s28, s14
    s_mov_b32 s29, s15
    s_mov_b32 s30, 1835008
    s_mov_b32 s31, 0x00020000
    s_mov_b32 s32, s16
    s_mov_b32 s33, s17
    s_mov_b32 s34, 1204224
    s_mov_b32 s35, 0x00020000
    s_lshl_b32 s45, s26, 7
    s_add_u32 s45, s45, s41
    s_mul_i32 s46, s26, 172032
    s_add_u32 s46, s46, s42
    s_mov_b32 m0, s44
    s_nop 0
    buffer_load_dwordx4 v2, s[28:31], s45 offen offset:0  lds
    buffer_load_dwordx4 v3, s[28:31], s45 offen offset:1024  lds
    buffer_load_dwordx4 v4, s[28:31], s45 offen offset:2048  lds
    buffer_load_dwordx4 v5, s[28:31], s45 offen offset:3072  lds
    s_add_u32 m0, s44, 16384
    s_nop 0
    buffer_load_dwordx4 v6, s[32:35], s46 offen offset:0  lds
    buffer_load_dwordx4 v7, s[32:35], s46 offen offset:1024  lds
    buffer_load_dwordx4 v8, s[32:35], s46 offen offset:2048  lds
    buffer_load_dwordx4 v9, s[32:35], s46 offen offset:3072  lds
    s_add_u32 s26, s26, 1
    s_cmp_eq_u32 s26, 7
    s_cselect_b32 s26, 0, s26
    s_add_u32 s44, s44, 0x8000
    s_and_b32 s44, s44, 0x1ffff
    s_load_dword s62, s[24:25], 0
    s_mov_b32 s36, s24
    s_mov_b32 s37, s25
    s_mov_b32 s38, 12648448
    s_mov_b32 s39, 0x00020000
    s_mov_b32 s48, 5
b1ld_3:
    s_lshl_b32 s45, s26, 7
    s_add_u32 s45, s45, s41
    s_mul_i32 s46, s26, 172032
    s_add_u32 s46, s46, s42
    s_mov_b32 m0, s44
    s_nop 0
    buffer_load_dwordx4 v2, s[28:31], s45 offen offset:0  lds
    buffer_load_dwordx4 v3, s[28:31], s45 offen offset:1024  lds
    buffer_load_dwordx4 v4, s[28:31], s45 offen offset:2048  lds
    buffer_load_dwordx4 v5, s[28:31], s45 offen offset:3072  lds
    s_add_u32 m0, s44, 16384
    s_nop 0
    buffer_load_dwordx4 v6, s[32:35], s46 offen offset:0  lds
    buffer_load_dwordx4 v7, s[32:35], s46 offen offset:1024  lds
    buffer_load_dwordx4 v8, s[32:35], s46 offen offset:2048  lds
    buffer_load_dwordx4 v9, s[32:35], s46 offen offset:3072  lds
    s_add_u32 s26, s26, 1
    s_cmp_eq_u32 s26, 7
    s_cselect_b32 s26, 0, s26
    s_add_u32 s44, s44, 0x8000
    s_and_b32 s44, s44, 0x1ffff
    s_waitcnt vmcnt(8)
    s_barrier
    s_sub_u32 s48, s48, 1
    s_cmp_lg_u32 s48, 0
    s_cbranch_scc1 b1ld_3
    s_lshl_b32 s45, s26, 7
    s_add_u32 s45, s45, s41
    s_mul_i32 s46, s26, 172032
    s_add_u32 s46, s46, s42
    s_mov_b32 m0, s44
    s_nop 0
    buffer_load_dwordx4 v2, s[28:31], s45 offen offset:0  lds
    buffer_load_dwordx4 v3, s[28:31], s45 offen offset:1024  lds
    buffer_load_dwordx4 v4, s[28:31], s45 offen offset:2048  lds
    buffer_load_dwordx4 v5, s[28:31], s45 offen offset:3072  lds
    s_add_u32 m0, s44, 16384
    s_nop 0
    buffer_load_dwordx4 v6, s[32:35], s46 offen offset:0  lds
    buffer_load_dwordx4 v7, s[32:35], s46 offen offset:1024  lds
    buffer_load_dwordx4 v8, s[32:35], s46 offen offset:2048  lds
    buffer_load_dwordx4 v9, s[32:35], s46 offen offset:3072  lds
    s_add_u32 s26, s26, 1
    s_cmp_eq_u32 s26, 7
    s_cselect_b32 s26, 0, s26
    s_add_u32 s44, s44, 0x8000
    s_and_b32 s44, s44, 0x1ffff
    s_waitcnt vmcnt(8)
    s_barrier
    s_waitcnt lgkmcnt(0)
    s_add_u32 s62, s62, 2654435769
    s_waitcnt vmcnt(0)
    s_barrier
    s_cmp_eq_u32 s7, 10
    s_cbranch_scc1 L_att
    s_branch L_att
L_a1:
    s_sub_u32 s5, s7, 11
    s_mul_i32 s26, s5, 3
    s_lshr_b32 s26, s26, 1
    s_cmp_lt_u32 s3, 4
    s_cbranch_scc1 L_a1c
    s_setprio 3
    s_lshl_b32 s96, s6, 2
    s_add_u32 s96, s96, s40
    s_mul_i32 s96, s96, 896
    s_lshl_b32 s97, s40, 12
    s_lshl_b32 s98, s26, 2
    s_add_u32 s98, s98, 3
    s_lshl_b32 s99, s6, 7
    s_add_u32 s99, s99, 4096
    s_mul_i32 s27, s98, 37
    s_lshr_b32 s27, s27, 8
    s_mul_i32 s27, s27, 7
    s_sub_u32 s98, s98, s27
    s_waitcnt lgkmcnt(0)
    s_mov_b32 s28, s14
    s_mov_b32 s29, s15
    s_mov_b32 s30, 1835008
    s_mov_b32 s31, 0x00020000
    s_lshr_b32 s42, s2, 3
    s_sub_u32 s42, s42, 22
    v_lshlrev_b32 v1, 7, v0
    s_cmp_eq_u32 s40, 3
    s_cbranch_scc1 pre_4
    s_mul_i32 s43, s42, 3
    s_add_u32 s43, s43, s40
    s_min_u32 s43, s43, 27
    s_lshl_b32 s43, s43, 13
    s_mul_i32 s44, s4, 229376
    s_add_u32 s43, s43, s44
    buffer_load_dword v45, v1, s[28:31], s43 offen
    s_branch pre_5
pre_4:
    s_mov_b32 s28, s16
    s_mov_b32 s29, s17
    s_mov_b32 s30, 1204224
    s_mov_b32 s31, 0x00020000
    s_lshl_b32 s43, s42, 3
    s_add_u32 s43, s43, s4
    s_lshl_b32 s43, s43, 13
    s_add_u32 s43, s43, 172032
    buffer_load_dword v45, v1, s[28:31], s43 offen
    s_add_u32 s43, s43, 655360
    buffer_load_dword v44, v1, s[28:31], s43 offen
pre_5:
    s_mov_b32 s28, s8
    s_mov_b32 s29, s9
    s_mov_b32 s30, 1835008
    s_mov_b32 s31, 0x00020000
    s_lshl_b32 s44, s5, 7
    s_add_u32 s43, s96, s44
    s_cmp_lt_u32 s5, 2
    s_cselect_b32 s44, 640, 0
    v_lshrrev_b32 v1, 5, v0
    v_mul_u32_u24 v1, s44, v1
    v_and_b32 v2, 31, v0
    v_mul_u32_u24 v2, 57344, v2
    v_add_u32 v1, v1, v2
    buffer_load_dword v46, v1, s[28:31], s43 offen
    s_load_dword s62, s[24:25], 0
    s_mov_b32 s36, s24
    s_mov_b32 s37, s25
    s_mov_b32 s38, 12648448
    s_mov_b32 s39, 0x00020000
    s_mov_b32 s0, s8
    s_mov_b32 s1, s9
    s_waitcnt lgkmcnt(0)
    s_add_u32 s62, s62, 2654435769
    s_branch L_att
L_a1ld:
    s_setprio 3
    v_mov_b32 v9, 0
    v_lshrrev_b32 v17, 3, v0
    v_and_b32 v14, 7, v0
    v_lshrrev_b32 v15, 4, v0
    v_xor_b32 v14, v14, v15
    v_lshlrev_b32 v14, 4, v14
    v_xor_b32 v16, 64, v14
    v_mul_u32_u24 v17, 57344, v17
    v_add_u32 v48, v17, v14
    v_add_u32 v49, v17, v16
    v_add_u32 v49, 457728, v49
    v_add_u32 v50, 915456, v48
    v_add_u32 v51, 915456, v49
    s_mov_b32 s28, s0
    s_mov_b32 s29, s1
    s_mov_b32 s30, 1835008
    s_mov_b32 s31, 0x00020000
    s_mov_b32 s61, 200000
spin_6:
    buffer_load_dword v14, v9, s[36:39], s99 offen sc1
    s_waitcnt vmcnt(0)
    v_cmp_ne_u32 vcc, s62, v14
    s_nop 0
    s_cbranch_vccz spinok_7
    s_sub_u32 s61, s61, 1
    s_cmp_eq_u32 s61, 0
    s_cbranch_scc1 spinok_7
    s_sleep 2
    s_branch spin_6
spinok_7:
    s_mov_b32 s100, 0
a1ld_8:
    s_lshl_b32 s42, s98, 7
    s_add_u32 s42, s42, s96
    s_lshl_b32 s43, s98, 14
    s_add_u32 m0, s97, s43
    s_nop 0
    buffer_load_dwordx4 v48, s[28:31], s42 offen offset:0 lds
    buffer_load_dwordx4 v49, s[28:31], s42 offen offset:1024 lds
    buffer_load_dwordx4 v50, s[28:31], s42 offen offset:2048 lds
    buffer_load_dwordx4 v51, s[28:31], s42 offen offset:3072 lds
    s_add_u32 s98, s98, 4
    s_sub_u32 s43, s98, 7
    s_cmp_ge_u32 s98, 7
    s_cselect_b32 s98, s43, s98
    s_add_u32 s100, s100, 1
    s_cmp_lt_u32 s100, 3
    s_cbranch_scc1 a1ld_8
    s_waitcnt vmcnt(4)
    s_barrier
    s_cmp_lt_u32 s100, 7
    s_cbranch_scc1 a1ld_8
    s_waitcnt vmcnt(0)
    s_barrier
    s_branch L_att2
L_b1c:
    s_setprio 2
    v_lshlrev_b32 v1, 4, v0
    v_add_u32 v1, 162828, v1
    v_mov_b32 v2, 0
    ds_write_b32 v1, v2
    v_mov_b32 v64, 0
    v_mov_b32 v65, 0
    v_mov_b32 v66, 0
    v_mov_b32 v67, 0
    v_mov_b32 v68, 0
    v_mov_b32 v69, 0
    v_mov_b32 v70, 0
    v_mov_b32 v71, 0
    v_mov_b32 v72, 0
    v_mov_b32 v73, 0
    v_mov_b32 v74, 0
    v_mov_b32 v75, 0
    v_mov_b32 v76, 0
    v_mov_b32 v77, 0
    v_mov_b32 v78, 0
    v_mov_b32 v79, 0
    v_mov_b32 v80, 0
    v_mov_b32 v81, 0
    v_mov_b32 v82, 0
    v_mov_b32 v83, 0
    v_mov_b32 v84, 0
    v_mov_b32 v85, 0
    v_mov_b32 v86, 0
    v_mov_b32 v87, 0
    v_mov_b32 v88, 0
    v_mov_b32 v89, 0
    v_mov_b32 v90, 0
    v_mov_b32 v91, 0
    v_mov_b32 v92, 0
    v_mov_b32 v93, 0
    v_mov_b32 v94, 0
    v_mov_b32 v95, 0
    v_mov_b32 v96, 0
    v_mov_b32 v97, 0
    v_mov_b32 v98, 0
    v_mov_b32 v99, 0
    v_mov_b32 v100, 0
    v_mov_b32 v101, 0
    v_mov_b32 v102, 0
    v_mov_b32 v103, 0
    v_mov_b32 v104, 0
    v_mov_b32 v105, 0
    v_mov_b32 v106, 0
    v_mov_b32 v107, 0
    v_mov_b32 v108, 0
    v_mov_b32 v109, 0
    v_mov_b32 v110, 0
    v_mov_b32 v111, 0
    v_mov_b32 v112, 0
    v_mov_b32 v113, 0
    v_mov_b32 v114, 0
    v_mov_b32 v115, 0
    v_mov_b32 v116, 0
    v_mov_b32 v117, 0
    v_mov_b32 v118, 0
    v_mov_b32 v119, 0
    v_mov_b32 v120, 0
    v_mov_b32 v121, 0
    v_mov_b32 v122, 0
    v_mov_b32 v123, 0
    v_mov_b32 v124, 0
    v_mov_b32 v125, 0
    v_mov_b32 v126, 0
    v_mov_b32 v127, 0
    s_waitcnt lgkmcnt(0)
    s_load_dword s62, s[24:25], 0
    s_mov_b32 s36, s24
    s_mov_b32 s37, s25
    s_mov_b32 s38, 12648448
    s_mov_b32 s39, 0x00020000
    v_and_b32 v14, 31, v0
    v_lshrrev_b32 v15, 5, v0
    s_lshr_b32 s50, s2, 5
    s_lshl_b32 s50, s50, 3
    s_or_b32 s50, s50, s4
    s_bfe_u32 s51, s2, 0x20003
    s_and_b32 s52, s40, 1
    s_and_b32 s41, s3, 1
    s_lshr_b32 s42, s3, 1
    s_waitcnt lgkmcnt(0)
    s_add_u32 s62, s62, 2654435769
    s_cmp_ge_u32 s7, 7
    s_cbranch_scc1 L_b1v
    v_mov_b32 v48, v14
    v_lshrrev_b32 v49, 1, v48
    v_and_b32 v49, 7, v49
    v_xor_b32 v49, v49, v15
    v_lshlrev_b32 v49, 4, v49
    v_lshl_or_b32 v50, v48, 7, v49
    s_lshl_b32 s43, s41, 13
    v_add_u32 v52, s43, v50
    v_xor_b32 v53, 32, v52
    v_xor_b32 v54, 64, v52
    v_xor_b32 v55, 96, v52
    v_bfe_u32 v48, v0, 2, 2
    v_and_b32 v49, 3, v0
    v_lshrrev_b32 v50, 1, v49
    v_and_b32 v49, 1, v49
    v_lshl_or_b32 v49, v49, 1, v50
    v_bfe_u32 v50, v0, 4, 1
    v_lshlrev_b32 v50, 5, v50
    v_lshl_or_b32 v50, v49, 3, v50
    s_lshl_b32 s43, s42, 7
    v_or_b32 v50, s43, v50
    v_lshlrev_b32 v51, 6, v48
    v_xor_b32 v50, v50, v51
    v_lshl_add_u32 v51, v15, 3, v48
    v_lshl_or_b32 v56, v51, 8, v50
    v_add_u32 v56, 16384, v56
    v_xor_b32 v57, 64, v56
    s_lshl_b32 s46, s6, 2
    s_lshl_b32 s47, s41, 1
    s_add_u32 s46, s46, s47
    s_lshl_b32 s47, s7, 2
    s_lshl_b32 s48, s42, 1
    s_add_u32 s47, s47, s48
    s_lshl_b32 s48, s47, 11
    v_lshlrev_b32 v2, 4, v0
    s_cmp_ge_u32 s47, 14
    s_cselect_b32 s49, 32768, 0
    s_cselect_b32 s43, 1806336, 0
    s_cselect_b32 s54, 1.0, 0x3e8b97f6
    s_mov_b32 s55, s54
    s_add_u32 s49, s49, 28672
    s_mul_i32 s46, s46, s49
    s_add_u32 s46, s46, s48
    s_add_u32 s46, s46, s43
    s_add_u32 s46, s46, 851968
    s_add_u32 s49, s46, s49
    s_mov_b32 s44, 0
    s_mov_b32 s45, 0
    v_add_u32 v6, s44, v52
    v_add_u32 v7, s44, v53
    v_add_u32 v8, s44, v54
    v_add_u32 v9, s44, v55
    v_add_u32 v10, s44, v56
    v_add_u32 v11, s44, v57
    s_cmp_lg_u32 s3, 3
    s_cbranch_scc1 pw_10
    s_sub_u32 s60, s62, 2654435769
    s_lshl_b32 s61, s7, 4
    s_add_u32 s61, s61, s6
    s_lshl_b32 s61, s61, 7
    s_add_u32 s61, s61, 65536
    v_lshrrev_b32 v12, 3, v0
    v_mul_u32_u24 v12, 32768, v12
    v_and_b32 v13, 7, v0
    v_lshl_add_u32 v12, v13, 4, v12
    v_mov_b32 v40, s60
    v_mov_b32 v41, s60
    v_mov_b32 v42, s60
    v_mov_b32 v43, s60
    buffer_store_dwordx4 v[40:43], v12, s[36:39], s61 offen sc1
pw_10:
    s_barrier
    ds_read_b128 v[16:19], v6 offset:0
    ds_read_b64_tr_b16 v[24:25], v10 offset:0
    ds_read_b64_tr_b16 v[26:27], v10 offset:1024
    ds_read_b64_tr_b16 v[28:29], v11 offset:0
    ds_read_b64_tr_b16 v[30:31], v11 offset:1024
    ds_read_b128 v[20:23], v6 offset:4096
b1loop_9:
    s_waitcnt lgkmcnt(3)
    v_mfma_f32_32x32x16_bf16 v[64:79], v[24:27], v[16:19], v[64:79]
    ds_read_b128 v[32:35], v7 offset:0
    ds_read_b64_tr_b16 v[40:41], v10 offset:4096
    ds_read_b64_tr_b16 v[42:43], v10 offset:5120
    s_waitcnt lgkmcnt(4)
    v_mfma_f32_32x32x16_bf16 v[80:95], v[28:31], v[16:19], v[80:95]
    ds_read_b64_tr_b16 v[44:45], v11 offset:4096
    ds_read_b64_tr_b16 v[46:47], v11 offset:5120
    s_waitcnt lgkmcnt(5)
    v_mfma_f32_32x32x16_bf16 v[96:111], v[24:27], v[20:23], v[96:111]
    ds_read_b128 v[36:39], v7 offset:4096
    v_mfma_f32_32x32x16_bf16 v[112:127], v[28:31], v[20:23], v[112:127]
    s_waitcnt lgkmcnt(3)
    v_mfma_f32_32x32x16_bf16 v[64:79], v[40:43], v[32:35], v[64:79]
    ds_read_b128 v[16:19], v8 offset:0
    ds_read_b64_tr_b16 v[24:25], v10 offset:8192
    ds_read_b64_tr_b16 v[26:27], v10 offset:9216
    s_waitcnt lgkmcnt(4)
    v_mfma_f32_32x32x16_bf16 v[80:95], v[44:47], v[32:35], v[80:95]
    ds_read_b64_tr_b16 v[28:29], v11 offset:8192
    ds_read_b64_tr_b16 v[30:31], v11 offset:9216
    s_waitcnt lgkmcnt(5)
    v_mfma_f32_32x32x16_bf16 v[96:111], v[40:43], v[36:39], v[96:111]
    ds_read_b128 v[20:23], v8 offset:4096
    v_mfma_f32_32x32x16_bf16 v[112:127], v[44:47], v[36:39], v[112:127]
    s_add_u32 s44, s44, 0x8000
    s_and_b32 s44, s44, 0x1ffff
    s_add_u32 s45, s45, 1
    s_waitcnt lgkmcnt(3)
    v_mfma_f32_32x32x16_bf16 v[64:79], v[24:27], v[16:19], v[64:79]
    ds_read_b128 v[32:35], v9 offset:0
    ds_read_b64_tr_b16 v[40:41], v10 offset:12288
    ds_read_b64_tr_b16 v[42:43], v10 offset:13312
    s_waitcnt lgkmcnt(4)
    v_mfma_f32_32x32x16_bf16 v[80:95], v[28:31], v[16:19], v[80:95]
    ds_read_b64_tr_b16 v[44:45], v11 offset:12288
    ds_read_b64_tr_b16 v[46:47], v11 offset:13312
    s_waitcnt lgkmcnt(5)
    v_mfma_f32_32x32x16_bf16 v[96:111], v[24:27], v[20:23], v[96:111]
    ds_read_b128 v[36:39], v9 offset:4096
    v_mfma_f32_32x32x16_bf16 v[112:127], v[28:31], v[20:23], v[112:127]
    v_add_u32 v6, s44, v52
    v_add_u32 v7, s44, v53
    v_add_u32 v8, s44, v54
    v_add_u32 v9, s44, v55
    v_add_u32 v10, s44, v56
    v_add_u32 v11, s44, v57
    s_barrier
    s_waitcnt lgkmcnt(3)
    v_mfma_f32_32x32x16_bf16 v[64:79], v[40:43], v[32:35], v[64:79]
    ds_read_b128 v[16:19], v6 offset:0
    ds_read_b64_tr_b16 v[24:25], v10 offset:0
    ds_read_b64_tr_b16 v[26:27], v10 offset:1024
    s_waitcnt lgkmcnt(4)
    v_mfma_f32_32x32x16_bf16 v[80:95], v[44:47], v[32:35], v[80:95]
    ds_read_b64_tr_b16 v[28:29], v11 offset:0
    ds_read_b64_tr_b16 v[30:31], v11 offset:1024
    s_waitcnt lgkmcnt(5)
    v_mfma_f32_32x32x16_bf16 v[96:111], v[40:43], v[36:39], v[96:111]
    ds_read_b128 v[20:23], v6 offset:4096
    v_mfma_f32_32x32x16_bf16 v[112:127], v[44:47], v[36:39], v[112:127]
    s_cmp_lt_u32 s45, 6
    s_cbranch_scc1 b1loop_9
    s_waitcnt lgkmcnt(3)
    v_mfma_f32_32x32x16_bf16 v[64:79], v[24:27], v[16:19], v[64:79]
    ds_read_b128 v[32:35], v7 offset:0
    ds_read_b64_tr_b16 v[40:41], v10 offset:4096
    ds_read_b64_tr_b16 v[42:43], v10 offset:5120
    s_waitcnt lgkmcnt(4)
    v_mfma_f32_32x32x16_bf16 v[80:95], v[28:31], v[16:19], v[80:95]
    ds_read_b128 v[192:195], v8 offset:0
    ds_read_b64_tr_b16 v[200:201], v10 offset:8192
    ds_read_b64_tr_b16 v[202:203], v10 offset:9216
    s_waitcnt lgkmcnt(6)
    v_mfma_f32_32x32x16_bf16 v[96:111], v[24:27], v[20:23], v[96:111]
    ds_read_b128 v[208:211], v9 offset:0
    ds_read_b64_tr_b16 v[216:217], v10 offset:12288
    ds_read_b64_tr_b16 v[218:219], v10 offset:13312
    v_mfma_f32_32x32x16_bf16 v[112:127], v[28:31], v[20:23], v[112:127]
    ds_read_b64_tr_b16 v[44:45], v11 offset:4096
    ds_read_b64_tr_b16 v[46:47], v11 offset:5120
    ds_read_b64_tr_b16 v[204:205], v11 offset:8192
    s_waitcnt lgkmcnt(9)
    v_mfma_f32_32x32x16_bf16 v[64:79], v[40:43], v[32:35], v[64:79]
    ds_read_b64_tr_b16 v[206:207], v11 offset:9216
    ds_read_b64_tr_b16 v[220:221], v11 offset:12288
    ds_read_b64_tr_b16 v[222:223], v11 offset:13312
    s_waitcnt lgkmcnt(9)
    v_mfma_f32_32x32x16_bf16 v[64:79], v[200:203], v[192:195], v[64:79]
    ds_read_b128 v[36:39], v7 offset:4096
    ds_read_b128 v[196:199], v8 offset:4096
    ds_read_b128 v[212:215], v9 offset:4096
    s_waitcnt lgkmcnt(9)
    v_mfma_f32_32x32x16_bf16 v[64:79], v[216:219], v[208:211], v[64:79]
    s_waitcnt lgkmcnt(7)
    v_mfma_f32_32x32x16_bf16 v[80:95], v[44:47], v[32:35], v[80:95]
    s_waitcnt lgkmcnt(5)
    v_mfma_f32_32x32x16_bf16 v[80:95], v[204:207], v[192:195], v[80:95]
    s_nop 7
    v_mul_f32 v64, s54, v64
    v_mul_f32 v65, s54, v65
    v_cvt_pk_bf16_f32 v64, v64, v65
    v_mul_f32 v66, s54, v66
    v_mul_f32 v67, s54, v67
    v_cvt_pk_bf16_f32 v65, v66, v67
    v_mul_f32 v68, s54, v68
    v_mul_f32 v69, s54, v69
    s_waitcnt lgkmcnt(3)
    v_mfma_f32_32x32x16_bf16 v[80:95], v[220:223], v[208:211], v[80:95]
    v_cvt_pk_bf16_f32 v66, v68, v69
    v_mul_f32 v70, s54, v70
    v_mul_f32 v71, s54, v71
    v_cvt_pk_bf16_f32 v67, v70, v71
    buffer_store_dwordx4 v[64:67], v2, s[36:39], s46 offen offset:0 sc1
    v_mul_f32 v72, s54, v72
    v_mul_f32 v73, s54, v73
    v_cvt_pk_bf16_f32 v68, v72, v73
    s_waitcnt lgkmcnt(2)
    v_mfma_f32_32x32x16_bf16 v[96:111], v[40:43], v[36:39], v[96:111]
    v_mul_f32 v74, s54, v74
    v_mul_f32 v75, s54, v75
    v_cvt_pk_bf16_f32 v69, v74, v75
    v_mul_f32 v76, s54, v76
    v_mul_f32 v77, s54, v77
    v_cvt_pk_bf16_f32 v70, v76, v77
    v_mul_f32 v78, s54, v78
    v_mul_f32 v79, s54, v79
    s_waitcnt lgkmcnt(1)
    v_mfma_f32_32x32x16_bf16 v[96:111], v[200:203], v[196:199], v[96:111]
    v_cvt_pk_bf16_f32 v71, v78, v79
    buffer_store_dwordx4 v[68:71], v2, s[36:39], s46 offen offset:1024 sc1
    v_mul_f32 v80, s54, v80
    v_mul_f32 v81, s54, v81
    v_cvt_pk_bf16_f32 v80, v80, v81
    v_mul_f32 v82, s54, v82
    v_mul_f32 v83, s54, v83
    v_cvt_pk_bf16_f32 v81, v82, v83
    s_waitcnt lgkmcnt(0)
    v_mfma_f32_32x32x16_bf16 v[96:111], v[216:219], v[212:215], v[96:111]
    v_mul_f32 v84, s54, v84
    v_mul_f32 v85, s54, v85
    v_cvt_pk_bf16_f32 v82, v84, v85
    v_mul_f32 v86, s54, v86
    v_mul_f32 v87, s54, v87
    v_cvt_pk_bf16_f32 v83, v86, v87
    buffer_store_dwordx4 v[80:83], v2, s[36:39], s46 offen offset:2048 sc1
    v_mul_f32 v88, s54, v88
    v_mfma_f32_32x32x16_bf16 v[112:127], v[44:47], v[36:39], v[112:127]
    v_mul_f32 v89, s54, v89
    v_cvt_pk_bf16_f32 v84, v88, v89
    v_mul_f32 v90, s54, v90
    v_mul_f32 v91, s54, v91
    v_cvt_pk_bf16_f32 v85, v90, v91
    v_mul_f32 v92, s54, v92
    v_mul_f32 v93, s54, v93
    v_cvt_pk_bf16_f32 v86, v92, v93
    v_mfma_f32_32x32x16_bf16 v[112:127], v[204:207], v[196:199], v[112:127]
    v_mul_f32 v94, s54, v94
    v_mul_f32 v95, s54, v95
    v_cvt_pk_bf16_f32 v87, v94, v95
    buffer_store_dwordx4 v[84:87], v2, s[36:39], s46 offen offset:3072 sc1
    v_mul_f32 v96, s54, v96
    v_mul_f32 v97, s54, v97
    v_cvt_pk_bf16_f32 v96, v96, v97
    v_mul_f32 v98, s54, v98
    v_mfma_f32_32x32x16_bf16 v[112:127], v[220:223], v[212:215], v[112:127]
    v_mul_f32 v99, s54, v99
    v_cvt_pk_bf16_f32 v97, v98, v99
    v_mul_f32 v100, s54, v100
    v_mul_f32 v101, s54, v101
    v_cvt_pk_bf16_f32 v98, v100, v101
    v_mul_f32 v102, s54, v102
    v_mul_f32 v103, s54, v103
    v_cvt_pk_bf16_f32 v99, v102, v103
    buffer_store_dwordx4 v[96:99], v2, s[36:39], s49 offen offset:0 sc1
    v_mul_f32 v104, s54, v104
    v_mul_f32 v105, s54, v105
    v_cvt_pk_bf16_f32 v100, v104, v105
    v_mul_f32 v106, s54, v106
    v_mul_f32 v107, s54, v107
    v_cvt_pk_bf16_f32 v101, v106, v107
    v_mul_f32 v108, s54, v108
    v_mul_f32 v109, s54, v109
    v_cvt_pk_bf16_f32 v102, v108, v109
    v_mul_f32 v110, s54, v110
    v_mul_f32 v111, s54, v111
    v_cvt_pk_bf16_f32 v103, v110, v111
    buffer_store_dwordx4 v[100:103], v2, s[36:39], s49 offen offset:1024 sc1
    v_pk_mul_f32 v[112:113], v[112:113], s[54:55]
    v_cvt_pk_bf16_f32 v112, v112, v113
    v_pk_mul_f32 v[114:115], v[114:115], s[54:55]
    v_cvt_pk_bf16_f32 v113, v114, v115
    v_pk_mul_f32 v[116:117], v[116:117], s[54:55]
    v_cvt_pk_bf16_f32 v114, v116, v117
    v_pk_mul_f32 v[118:119], v[118:119], s[54:55]
    v_cvt_pk_bf16_f32 v115, v118, v119
    buffer_store_dwordx4 v[112:115], v2, s[36:39], s49 offen offset:2048 sc1
    v_pk_mul_f32 v[120:121], v[120:121], s[54:55]
    v_cvt_pk_bf16_f32 v116, v120, v121
    v_pk_mul_f32 v[122:123], v[122:123], s[54:55]
    v_cvt_pk_bf16_f32 v117, v122, v123
    v_pk_mul_f32 v[124:125], v[124:125], s[54:55]
    v_cvt_pk_bf16_f32 v118, v124, v125
    v_pk_mul_f32 v[126:127], v[126:127], s[54:55]
    v_cvt_pk_bf16_f32 v119, v126, v127
    buffer_store_dwordx4 v[116:119], v2, s[36:39], s49 offen offset:3072 sc1
    v_mov_b32 v12, 163068
    v_mov_b32 v13, 1
    s_mov_b64 exec, 1
    ds_add_u32 v12, v13
    s_mov_b64 exec, -1
    s_branch L_pub1
L_b1v:
    v_and_b32 v48, 0x13, v14
    v_and_b32 v49, 4, v14
    v_lshl_or_b32 v48, v49, 1, v48
    v_and_b32 v49, 8, v14
    v_lshrrev_b32 v49, 1, v49
    v_or_b32 v48, v48, v49
    v_lshrrev_b32 v49, 1, v48
    v_and_b32 v49, 7, v49
    v_xor_b32 v49, v49, v15
    v_lshlrev_b32 v49, 4, v49
    v_lshl_or_b32 v50, v48, 7, v49
    s_lshl_b32 s43, s41, 13
    v_add_u32 v52, s43, v50
    v_xor_b32 v53, 32, v52
    v_xor_b32 v54, 64, v52
    v_xor_b32 v55, 96, v52
    v_bfe_u32 v48, v0, 2, 2
    v_and_b32 v49, 3, v0
    v_bfe_u32 v50, v0, 4, 1
    v_lshlrev_b32 v50, 5, v50
    v_lshl_or_b32 v50, v49, 3, v50
    s_lshl_b32 s43, s42, 7
    v_or_b32 v50, s43, v50
    v_lshlrev_b32 v51, 6, v48
    v_xor_b32 v50, v50, v51
    v_lshl_add_u32 v51, v15, 3, v48
    v_lshl_or_b32 v56, v51, 8, v50
    v_add_u32 v56, 16384, v56
    v_xor_b32 v57, 64, v56
    s_lshl_b32 s46, s6, 2
    s_lshl_b32 s47, s41, 1
    s_add_u32 s46, s46, s47
    s_lshl_b32 s47, s7, 2
    s_lshl_b32 s48, s42, 1
    s_add_u32 s47, s47, s48
    s_sub_u32 s45, s7, 7
    s_lshl_b32 s45, s45, 7
    s_add_u32 s45, s45, 27
    s_mul_i32 s45, s45, 2341
    s_lshr_b32 s45, s45, 16
    v_lshrrev_b32 v10, 4, v0
    v_add_u32 v10, s45, v10
    v_lshrrev_b32 v11, 2, v0
    v_lshlrev_b32 v11, 9, v11
    s_lshl_b32 s45, s45, 11
    v_add_u32 v11, s45, v11
    v_cmp_gt_u32 s[56:57], 16, v10
    v_and_b32 v4, 3, v0
    v_lshl_or_b32 v4, v4, 4, v11
    s_cmp_lt_u32 s7, 9
    s_cselect_b32 s58, 0xffff, 0
    s_mov_b32 s59, 0
    s_lshl_b32 s54, s6, 2
    s_add_u32 s54, s54, s40
    s_mul_i32 s54, s54, 61440
    s_add_u32 s54, s54, 2716096
    s_add_u32 s55, s54, 8192
    v_and_b32 v58, 1, v0
    v_add_u32 v58, -1, v58
    v_and_b32 v58, 0x3f803f80, v58
    v_mov_b32 v59, v58
    v_mov_b32 v60, v58
    v_mov_b32 v61, v58
    s_sub_u32 s47, s47, 28
    s_mul_i32 s46, s46, 61440
    s_add_u32 s46, s46, 2715648
    s_add_u32 s49, s46, 61440
    s_lshl_b32 s48, s47, 5
    v_add_u32 v48, s48, v14
    v_add_u32 v48, 0, v48
    v_mul_u32_u24 v49, 2341, v48
    v_lshrrev_b32 v49, 16, v49
    v_mul_u32_u24 v50, 28, v49
    v_sub_u32 v48, v48, v50
    v_lshlrev_b32 v48, 4, v48
    v_lshl_or_b32 v48, v15, 9, v48
    v_lshl_or_b32 v2, v49, 11, v48
    v_add_u32 v48, s48, v14
    v_add_u32 v48, 32, v48
    v_mul_u32_u24 v49, 2341, v48
    v_lshrrev_b32 v49, 16, v49
    v_mul_u32_u24 v50, 28, v49
    v_sub_u32 v48, v48, v50
    v_lshlrev_b32 v48, 4, v48
    v_lshl_or_b32 v48, v15, 9, v48
    v_lshl_or_b32 v3, v49, 11, v48
    s_cmp_lt_u32 s47, 14
    s_cbranch_scc1 idle_12
    s_cmp_lg_u32 s3, 3
    s_cbranch_scc1 pw_14
    s_sub_u32 s60, s62, 2654435769
    s_lshl_b32 s61, s7, 4
    s_add_u32 s61, s61, s6
    s_lshl_b32 s61, s61, 7
    s_add_u32 s61, s61, 65536
    v_lshrrev_b32 v12, 3, v0
    v_mul_u32_u24 v12, 32768, v12
    v_and_b32 v13, 7, v0
    v_lshl_add_u32 v12, v13, 4, v12
    v_mov_b32 v40, s60
    v_mov_b32 v41, s60
    v_mov_b32 v42, s60
    v_mov_b32 v43, s60
    buffer_store_dwordx4 v[40:43], v12, s[36:39], s61 offen sc1
pw_14:
    s_barrier
    s_barrier
    s_barrier
    s_cmp_lg_u32 s3, 2
    s_cbranch_scc1 idle_13
    s_lshl_b32 s61, s6, 7
    s_add_u32 s61, s61, 4096
    v_lshrrev_b32 v12, 3, v0
    v_mul_u32_u24 v12, 0, v12
    v_and_b32 v13, 7, v0
    v_lshl_add_u32 v12, v13, 4, v12
    v_mov_b32 v40, s62
    v_mov_b32 v41, s62
    v_mov_b32 v42, s62
    v_mov_b32 v43, s62
    s_bfm_b64 exec, 8, 0
    buffer_store_dwordx4 v[40:43], v12, s[36:39], s61 offen sc1
    s_mov_b64 exec, -1
idle_13:
    s_barrier
    s_barrier
    s_barrier
    s_barrier
    s_mov_b64 exec, s[56:57]
    buffer_store_dwordx4 v[58:61], v4, s[36:39], s54 offen sc1
    s_mov_b64 exec, s[58:59]
    s_cbranch_execz ones_15
    buffer_store_dwordx4 v[58:61], v4, s[36:39], s55 offen sc1
ones_15:
    s_mov_b64 exec, -1
    s_branch L_ones
idle_12:
    s_mov_b32 s44, 0
    s_mov_b32 s45, 0
    v_add_u32 v6, s44, v52
    v_add_u32 v7, s44, v53
    v_add_u32 v8, s44, v54
    v_add_u32 v9, s44, v55
    v_add_u32 v10, s44, v56
    v_add_u32 v11, s44, v57
    s_cmp_lg_u32 s3, 3
    s_cbranch_scc1 pw_16
    s_sub_u32 s60, s62, 2654435769
    s_lshl_b32 s61, s7, 4
    s_add_u32 s61, s61, s6
    s_lshl_b32 s61, s61, 7
    s_add_u32 s61, s61, 65536
    v_lshrrev_b32 v12, 3, v0
    v_mul_u32_u24 v12, 32768, v12
    v_and_b32 v13, 7, v0
    v_lshl_add_u32 v12, v13, 4, v12
    v_mov_b32 v40, s60
    v_mov_b32 v41, s60
    v_mov_b32 v42, s60
    v_mov_b32 v43, s60
    buffer_store_dwordx4 v[40:43], v12, s[36:39], s61 offen sc1
pw_16:
    s_barrier
    ds_read_b128 v[16:19], v6 offset:0
    ds_read_b64_tr_b16 v[24:25], v10 offset:0
    ds_read_b64_tr_b16 v[26:27], v10 offset:1024
    ds_read_b64_tr_b16 v[28:29], v11 offset:0
    ds_read_b64_tr_b16 v[30:31], v11 offset:1024
    ds_read_b128 v[20:23], v6 offset:4096
b1loop_11:
    s_waitcnt lgkmcnt(3)
    v_mfma_f32_32x32x16_bf16 v[64:79], v[16:19], v[24:27], v[64:79]
    ds_read_b128 v[32:35], v7 offset:0
    ds_read_b64_tr_b16 v[40:41], v10 offset:4096
    ds_read_b64_tr_b16 v[42:43], v10 offset:5120
    s_waitcnt lgkmcnt(4)
    v_mfma_f32_32x32x16_bf16 v[80:95], v[16:19], v[28:31], v[80:95]
    ds_read_b64_tr_b16 v[44:45], v11 offset:4096
    ds_read_b64_tr_b16 v[46:47], v11 offset:5120
    s_waitcnt lgkmcnt(5)
    v_mfma_f32_32x32x16_bf16 v[96:111], v[20:23], v[24:27], v[96:111]
    ds_read_b128 v[36:39], v7 offset:4096
    v_mfma_f32_32x32x16_bf16 v[112:127], v[20:23], v[28:31], v[112:127]
    s_waitcnt lgkmcnt(3)
    v_mfma_f32_32x32x16_bf16 v[64:79], v[32:35], v[40:43], v[64:79]
    ds_read_b128 v[16:19], v8 offset:0
    ds_read_b64_tr_b16 v[24:25], v10 offset:8192
    ds_read_b64_tr_b16 v[26:27], v10 offset:9216
    s_waitcnt lgkmcnt(4)
    v_mfma_f32_32x32x16_bf16 v[80:95], v[32:35], v[44:47], v[80:95]
    ds_read_b64_tr_b16 v[28:29], v11 offset:8192
    ds_read_b64_tr_b16 v[30:31], v11 offset:9216
    s_waitcnt lgkmcnt(5)
    v_mfma_f32_32x32x16_bf16 v[96:111], v[36:39], v[40:43], v[96:111]
    ds_read_b128 v[20:23], v8 offset:4096
    v_mfma_f32_32x32x16_bf16 v[112:127], v[36:39], v[44:47], v[112:127]
    s_add_u32 s44, s44, 0x8000
    s_and_b32 s44, s44, 0x1ffff
    s_add_u32 s45, s45, 1
    s_waitcnt lgkmcnt(3)
    v_mfma_f32_32x32x16_bf16 v[64:79], v[16:19], v[24:27], v[64:79]
    ds_read_b128 v[32:35], v9 offset:0
    ds_read_b64_tr_b16 v[40:41], v10 offset:12288
    ds_read_b64_tr_b16 v[42:43], v10 offset:13312
    s_waitcnt lgkmcnt(4)
    v_mfma_f32_32x32x16_bf16 v[80:95], v[16:19], v[28:31], v[80:95]
    ds_read_b64_tr_b16 v[44:45], v11 offset:12288
    ds_read_b64_tr_b16 v[46:47], v11 offset:13312
    s_waitcnt lgkmcnt(5)
    v_mfma_f32_32x32x16_bf16 v[96:111], v[20:23], v[24:27], v[96:111]
    ds_read_b128 v[36:39], v9 offset:4096
    v_mfma_f32_32x32x16_bf16 v[112:127], v[20:23], v[28:31], v[112:127]
    v_add_u32 v6, s44, v52
    v_add_u32 v7, s44, v53
    v_add_u32 v8, s44, v54
    v_add_u32 v9, s44, v55
    v_add_u32 v10, s44, v56
    v_add_u32 v11, s44, v57
    s_barrier
    s_waitcnt lgkmcnt(3)
    v_mfma_f32_32x32x16_bf16 v[64:79], v[32:35], v[40:43], v[64:79]
    ds_read_b128 v[16:19], v6 offset:0
    ds_read_b64_tr_b16 v[24:25], v10 offset:0
    ds_read_b64_tr_b16 v[26:27], v10 offset:1024
    s_waitcnt lgkmcnt(4)
    v_mfma_f32_32x32x16_bf16 v[80:95], v[32:35], v[44:47], v[80:95]
    ds_read_b64_tr_b16 v[28:29], v11 offset:0
    ds_read_b64_tr_b16 v[30:31], v11 offset:1024
    s_waitcnt lgkmcnt(5)
    v_mfma_f32_32x32x16_bf16 v[96:111], v[36:39], v[40:43], v[96:111]
    ds_read_b128 v[20:23], v6 offset:4096
    v_mfma_f32_32x32x16_bf16 v[112:127], v[36:39], v[44:47], v[112:127]
    s_cmp_lt_u32 s45, 6
    s_cbranch_scc1 b1loop_11
    s_waitcnt lgkmcnt(3)
    v_mfma_f32_32x32x16_bf16 v[64:79], v[16:19], v[24:27], v[64:79]
    ds_read_b128 v[32:35], v7 offset:0
    ds_read_b64_tr_b16 v[40:41], v10 offset:4096
    ds_read_b64_tr_b16 v[42:43], v10 offset:5120
    s_waitcnt lgkmcnt(4)
    v_mfma_f32_32x32x16_bf16 v[80:95], v[16:19], v[28:31], v[80:95]
    ds_read_b128 v[192:195], v8 offset:0
    ds_read_b64_tr_b16 v[200:201], v10 offset:8192
    ds_read_b64_tr_b16 v[202:203], v10 offset:9216
    s_waitcnt lgkmcnt(6)
    v_mfma_f32_32x32x16_bf16 v[96:111], v[20:23], v[24:27], v[96:111]
    ds_read_b128 v[208:211], v9 offset:0
    ds_read_b64_tr_b16 v[216:217], v10 offset:12288
    ds_read_b64_tr_b16 v[218:219], v10 offset:13312
    v_mfma_f32_32x32x16_bf16 v[112:127], v[20:23], v[28:31], v[112:127]
    ds_read_b64_tr_b16 v[44:45], v11 offset:4096
    ds_read_b64_tr_b16 v[46:47], v11 offset:5120
    ds_read_b64_tr_b16 v[204:205], v11 offset:8192
    s_waitcnt lgkmcnt(9)
    v_mfma_f32_32x32x16_bf16 v[64:79], v[32:35], v[40:43], v[64:79]
    ds_read_b64_tr_b16 v[206:207], v11 offset:9216
    ds_read_b64_tr_b16 v[220:221], v11 offset:12288
    ds_read_b64_tr_b16 v[222:223], v11 offset:13312
    s_waitcnt lgkmcnt(9)
    v_mfma_f32_32x32x16_bf16 v[64:79], v[192:195], v[200:203], v[64:79]
    ds_read_b128 v[36:39], v7 offset:4096
    ds_read_b128 v[196:199], v8 offset:4096
    ds_read_b128 v[212:215], v9 offset:4096
    s_mov_b64 exec, s[56:57]
    buffer_store_dwordx4 v[58:61], v4, s[36:39], s54 offen sc1
    s_mov_b64 exec, s[58:59]
    s_cbranch_execz ones_17
    buffer_store_dwordx4 v[58:61], v4, s[36:39], s55 offen sc1
ones_17:
    s_mov_b64 exec, -1
    s_waitcnt lgkmcnt(9)
    v_mfma_f32_32x32x16_bf16 v[64:79], v[208:211], v[216:219], v[64:79]
    s_waitcnt lgkmcnt(7)
    v_mfma_f32_32x32x16_bf16 v[80:95], v[32:35], v[44:47], v[80:95]
    s_waitcnt lgkmcnt(5)
    v_mfma_f32_32x32x16_bf16 v[80:95], v[192:195], v[204:207], v[80:95]
    s_nop 7
    v_cvt_pk_bf16_f32 v64, v64, v65
    v_cvt_pk_bf16_f32 v65, v66, v67
    v_cvt_pk_bf16_f32 v66, v68, v69
    v_cvt_pk_bf16_f32 v67, v70, v71
    s_waitcnt lgkmcnt(3)
    v_mfma_f32_32x32x16_bf16 v[80:95], v[208:211], v[220:223], v[80:95]
    buffer_store_dwordx4 v[64:67], v2, s[36:39], s46 offen offset:0 sc1
    v_cvt_pk_bf16_f32 v68, v72, v73
    v_cvt_pk_bf16_f32 v69, v74, v75
    v_cvt_pk_bf16_f32 v70, v76, v77
    s_waitcnt lgkmcnt(2)
    v_mfma_f32_32x32x16_bf16 v[96:111], v[36:39], v[40:43], v[96:111]
    v_cvt_pk_bf16_f32 v71, v78, v79
    buffer_store_dwordx4 v[68:71], v2, s[36:39], s46 offen offset:1024 sc1
    s_waitcnt lgkmcnt(1)
    v_mfma_f32_32x32x16_bf16 v[96:111], v[196:199], v[200:203], v[96:111]
    s_nop 1
    v_cvt_pk_bf16_f32 v80, v80, v81
    v_cvt_pk_bf16_f32 v81, v82, v83
    v_cvt_pk_bf16_f32 v82, v84, v85
    v_cvt_pk_bf16_f32 v83, v86, v87
    s_waitcnt lgkmcnt(0)
    v_mfma_f32_32x32x16_bf16 v[96:111], v[212:215], v[216:219], v[96:111]
    buffer_store_dwordx4 v[80:83], v3, s[36:39], s46 offen offset:0 sc1
    v_cvt_pk_bf16_f32 v84, v88, v89
    v_cvt_pk_bf16_f32 v85, v90, v91
    v_cvt_pk_bf16_f32 v86, v92, v93
    v_mfma_f32_32x32x16_bf16 v[112:127], v[36:39], v[44:47], v[112:127]
    v_cvt_pk_bf16_f32 v87, v94, v95
    buffer_store_dwordx4 v[84:87], v3, s[36:39], s46 offen offset:1024 sc1
    v_mfma_f32_32x32x16_bf16 v[112:127], v[196:199], v[204:207], v[112:127]
    s_nop 3
    v_cvt_pk_bf16_f32 v96, v96, v97
    v_cvt_pk_bf16_f32 v97, v98, v99
    v_cvt_pk_bf16_f32 v98, v100, v101
    v_cvt_pk_bf16_f32 v99, v102, v103
    v_mfma_f32_32x32x16_bf16 v[112:127], v[212:215], v[220:223], v[112:127]
    buffer_store_dwordx4 v[96:99], v2, s[36:39], s49 offen offset:0 sc1
    v_cvt_pk_bf16_f32 v100, v104, v105
    v_cvt_pk_bf16_f32 v101, v106, v107
    v_cvt_pk_bf16_f32 v102, v108, v109
    v_cvt_pk_bf16_f32 v103, v110, v111
    buffer_store_dwordx4 v[100:103], v2, s[36:39], s49 offen offset:1024 sc1
    s_nop 5
    v_cvt_pk_bf16_f32 v112, v112, v113
    v_cvt_pk_bf16_f32 v113, v114, v115
    v_cvt_pk_bf16_f32 v114, v116, v117
    v_cvt_pk_bf16_f32 v115, v118, v119
    buffer_store_dwordx4 v[112:115], v3, s[36:39], s49 offen offset:0 sc1
    v_cvt_pk_bf16_f32 v116, v120, v121
    v_cvt_pk_bf16_f32 v117, v122, v123
    v_cvt_pk_bf16_f32 v118, v124, v125
    v_cvt_pk_bf16_f32 v119, v126, v127
    buffer_store_dwordx4 v[116:119], v3, s[36:39], s49 offen offset:1024 sc1
L_ones:
    v_mov_b32 v12, 163068
    v_mov_b32 v13, 1
    s_mov_b64 exec, 1
    ds_add_u32 v12, v13
    s_mov_b64 exec, -1
    s_branch L_pub1
L_a1c:
    s_setprio 2
    v_and_b32 v14, 31, v0
    v_lshrrev_b32 v15, 5, v0
    s_lshr_b32 s50, s2, 5
    s_lshl_b32 s50, s50, 3
    s_or_b32 s50, s50, s4
    s_bfe_u32 s51, s2, 0x20003
    s_and_b32 s52, s40, 1
    v_and_b32 v48, 0x13, v14
    v_and_b32 v49, 4, v14
    v_lshl_or_b32 v48, v49, 1, v48
    v_and_b32 v49, 8, v14
    v_lshrrev_b32 v49, 1, v49
    v_or_b32 v48, v48, v49
    v_lshlrev_b32 v61, 4, v0
    v_add_u32 v61, 114688, v61
    v_lshlrev_b32 v1, 4, v0
    v_add_u32 v1, 162828, v1
    v_mov_b32 v2, 0
    ds_write_b32 v1, v2
    v_lshrrev_b32 v48, 1, v48
    s_mul_i32 s41, s5, 3
    s_add_u32 s41, s41, s3
    s_lshl_b32 s41, s41, 4
    v_add_u32 v48, s41, v48
    v_cvt_f32_u32 v48, v48
    v_mul_f32 v56, 0x3b124925, v48
    v_and_b32 v48, 1, v14
    v_cvt_f32_u32 v48, v48
    v_mul_f32 v59, 0x3e800000, v48
    v_lshlrev_b32 v60, 3, v15
    v_cvt_f32_u32 v60, v60
    v_fma_f32 v59, v56, v60, v59
    v_mul_f32 v58, 0x41800000, v56
    v_cos_f32 v58, v58
    s_mul_i32 s41, s3, 14336
    v_add_u32 v53, s41, v61
    v_fmamk_f32 v16, v56, 0x00000000, v59
    v_fmamk_f32 v17, v56, 0x3f800000, v59
    v_fmamk_f32 v18, v56, 0x40000000, v59
    v_fmamk_f32 v19, v56, 0x40400000, v59
    v_fmamk_f32 v20, v56, 0x40800000, v59
    v_fmamk_f32 v21, v56, 0x40a00000, v59
    v_fmamk_f32 v22, v56, 0x40c00000, v59
    v_fmamk_f32 v23, v56, 0x40e00000, v59
    v_fmamk_f32 v24, v56, 0x41800000, v59
    v_fmamk_f32 v25, v56, 0x41880000, v59
    v_fmamk_f32 v26, v56, 0x41900000, v59
    v_fmamk_f32 v27, v56, 0x41980000, v59
    v_fmamk_f32 v28, v56, 0x41a00000, v59
    v_fmamk_f32 v29, v56, 0x41a80000, v59
    v_fmamk_f32 v30, v56, 0x41b00000, v59
    v_fmamk_f32 v31, v56, 0x41b80000, v59
    v_add_f32 v58, v58, v58
    v_cos_f32 v16, v16
    v_cos_f32 v17, v17
    v_cos_f32 v18, v18
    v_cos_f32 v19, v19
    v_cos_f32 v20, v20
    v_cos_f32 v21, v21
    v_cos_f32 v22, v22
    v_cos_f32 v23, v23
    v_cos_f32 v24, v24
    v_cos_f32 v25, v25
    v_cos_f32 v26, v26
    v_cos_f32 v27, v27
    v_cos_f32 v28, v28
    v_cos_f32 v29, v29
    v_cos_f32 v30, v30
    v_cos_f32 v31, v31
    s_waitcnt lgkmcnt(0)
    s_load_dword s62, s[24:25], 0
    s_mov_b32 s36, s24
    s_mov_b32 s37, s25
    s_mov_b32 s38, 12648448
    s_mov_b32 s39, 0x00020000
    s_cmp_eq_u32 s3, 3
    s_cbranch_scc1 fend_19
    v_mov_b32 v59, v58
    s_mov_b32 s42, 7
fgen_18:
    v_cvt_pk_bf16_f32 v32, v16, v17
    v_cvt_pk_bf16_f32 v33, v18, v19
    v_cvt_pk_bf16_f32 v34, v20, v21
    v_cvt_pk_bf16_f32 v35, v22, v23
    ds_write_b128 v53, v[32:35] offset:0
    v_pk_fma_f32 v[16:17], v[24:25], v[58:59], v[16:17] neg_lo:[0,0,1] neg_hi:[0,0,1]
    v_pk_fma_f32 v[18:19], v[26:27], v[58:59], v[18:19] neg_lo:[0,0,1] neg_hi:[0,0,1]
    v_pk_fma_f32 v[20:21], v[28:29], v[58:59], v[20:21] neg_lo:[0,0,1] neg_hi:[0,0,1]
    v_pk_fma_f32 v[22:23], v[30:31], v[58:59], v[22:23] neg_lo:[0,0,1] neg_hi:[0,0,1]
    v_cvt_pk_bf16_f32 v36, v24, v25
    v_cvt_pk_bf16_f32 v37, v26, v27
    v_cvt_pk_bf16_f32 v38, v28, v29
    v_cvt_pk_bf16_f32 v39, v30, v31
    ds_write_b128 v53, v[36:39] offset:1024
    v_pk_fma_f32 v[24:25], v[16:17], v[58:59], v[24:25] neg_lo:[0,0,1] neg_hi:[0,0,1]
    v_pk_fma_f32 v[26:27], v[18:19], v[58:59], v[26:27] neg_lo:[0,0,1] neg_hi:[0,0,1]
    v_pk_fma_f32 v[28:29], v[20:21], v[58:59], v[28:29] neg_lo:[0,0,1] neg_hi:[0,0,1]
    v_pk_fma_f32 v[30:31], v[22:23], v[58:59], v[30:31] neg_lo:[0,0,1] neg_hi:[0,0,1]
    v_add_u32 v53, 2048, v53
    s_sub_u32 s42, s42, 1
    s_cmp_lg_u32 s42, 0
    s_cbranch_scc1 fgen_18
fend_19:
L_gen:
    v_lshlrev_b32 v8, 6, v14
    v_add_u32 v8, s50, v8
    v_cvt_f32_u32 v8, v8
    v_mul_f32 v8, 0x3a000000, v8
    v_lshlrev_b32 v9, 2, v15
    v_cvt_f32_u32 v9, v9
    v_mul_f32 v9, v8, v9
    v_mul_f32 v11, 0x41000000, v8
    v_fmamk_f32 v32, v8, 0x00000000, v9
    v_fmamk_f32 v33, v8, 0x3f800000, v9
    v_fmamk_f32 v34, v8, 0x40000000, v9
    v_fmamk_f32 v35, v8, 0x40400000, v9
    v_cos_f32 v10, v11
    v_sin_f32 v12, v11
    v_cos_f32 v16, v32
    v_sin_f32 v24, v32
    v_cos_f32 v17, v33
    v_sin_f32 v25, v33
    v_cos_f32 v18, v34
    v_sin_f32 v26, v34
    v_cos_f32 v19, v35
    v_sin_f32 v27, v35
    v_mov_b32 v11, v10
    v_mov_b32 v13, v12
    v_mul_f32 v16, 0x36124925, v16
    v_mul_f32 v24, 0x36124925, v24
    v_mul_f32 v17, 0x36124925, v17
    v_mul_f32 v25, 0x36124925, v25
    v_mul_f32 v18, 0x36124925, v18
    v_mul_f32 v26, 0x36124925, v26
    v_mul_f32 v19, 0x36124925, v19
    v_mul_f32 v27, 0x36124925, v27
    v_cvt_pk_bf16_f32 v160, v16, -v24
    v_cvt_pk_bf16_f32 v161, v17, -v25
    v_cvt_pk_bf16_f32 v162, v18, -v26
    v_cvt_pk_bf16_f32 v163, v19, -v27
    v_cvt_pk_bf16_f32 v176, v24, v16
    v_cvt_pk_bf16_f32 v177, v25, v17
    v_cvt_pk_bf16_f32 v178, v26, v18
    v_cvt_pk_bf16_f32 v179, v27, v19
    v_pk_mul_f32 v[32:33], v[24:25], v[12:13]
    v_pk_mul_f32 v[34:35], v[26:27], v[12:13]
    v_pk_mul_f32 v[24:25], v[24:25], v[10:11]
    v_pk_mul_f32 v[26:27], v[26:27], v[10:11]
    v_pk_fma_f32 v[24:25], v[16:17], v[12:13], v[24:25]
    v_pk_fma_f32 v[26:27], v[18:19], v[12:13], v[26:27]
    v_pk_fma_f32 v[16:17], v[16:17], v[10:11], v[32:33] neg_lo:[0,0,1] neg_hi:[0,0,1]
    v_pk_fma_f32 v[18:19], v[18:19], v[10:11], v[34:35] neg_lo:[0,0,1] neg_hi:[0,0,1]
    v_cvt_pk_bf16_f32 v164, v16, -v24
    v_cvt_pk_bf16_f32 v165, v17, -v25
    v_cvt_pk_bf16_f32 v166, v18, -v26
    v_cvt_pk_bf16_f32 v167, v19, -v27
    v_cvt_pk_bf16_f32 v180, v24, v16
    v_cvt_pk_bf16_f32 v181, v25, v17
    v_cvt_pk_bf16_f32 v182, v26, v18
    v_cvt_pk_bf16_f32 v183, v27, v19
    v_pk_mul_f32 v[32:33], v[24:25], v[12:13]
    v_pk_mul_f32 v[34:35], v[26:27], v[12:13]
    v_pk_mul_f32 v[24:25], v[24:25], v[10:11]
    v_pk_mul_f32 v[26:27], v[26:27], v[10:11]
    v_pk_fma_f32 v[24:25], v[16:17], v[12:13], v[24:25]
    v_pk_fma_f32 v[26:27], v[18:19], v[12:13], v[26:27]
    v_pk_fma_f32 v[16:17], v[16:17], v[10:11], v[32:33] neg_lo:[0,0,1] neg_hi:[0,0,1]
    v_pk_fma_f32 v[18:19], v[18:19], v[10:11], v[34:35] neg_lo:[0,0,1] neg_hi:[0,0,1]
    v_cvt_pk_bf16_f32 v168, v16, -v24
    v_cvt_pk_bf16_f32 v169, v17, -v25
    v_cvt_pk_bf16_f32 v170, v18, -v26
    v_cvt_pk_bf16_f32 v171, v19, -v27
    v_cvt_pk_bf16_f32 v184, v24, v16
    v_cvt_pk_bf16_f32 v185, v25, v17
    v_cvt_pk_bf16_f32 v186, v26, v18
    v_cvt_pk_bf16_f32 v187, v27, v19
    v_pk_mul_f32 v[32:33], v[24:25], v[12:13]
    v_pk_mul_f32 v[34:35], v[26:27], v[12:13]
    v_pk_mul_f32 v[24:25], v[24:25], v[10:11]
    v_pk_mul_f32 v[26:27], v[26:27], v[10:11]
    v_pk_fma_f32 v[24:25], v[16:17], v[12:13], v[24:25]
    v_pk_fma_f32 v[26:27], v[18:19], v[12:13], v[26:27]
    v_pk_fma_f32 v[16:17], v[16:17], v[10:11], v[32:33] neg_lo:[0,0,1] neg_hi:[0,0,1]
    v_pk_fma_f32 v[18:19], v[18:19], v[10:11], v[34:35] neg_lo:[0,0,1] neg_hi:[0,0,1]
    v_cvt_pk_bf16_f32 v172, v16, -v24
    v_cvt_pk_bf16_f32 v173, v17, -v25
    v_cvt_pk_bf16_f32 v174, v18, -v26
    v_cvt_pk_bf16_f32 v175, v19, -v27
    v_cvt_pk_bf16_f32 v188, v24, v16
    v_cvt_pk_bf16_f32 v189, v25, v17
    v_cvt_pk_bf16_f32 v190, v26, v18
    v_cvt_pk_bf16_f32 v191, v27, v19
    s_lshr_b32 s44, s40, 1
    s_lshl_b32 s45, s51, 1
    s_add_u32 s44, s44, s45
    s_lshl_b32 s46, s44, 5
    v_add_u32 v8, s46, v14
    v_cvt_f32_u32 v8, v8
    v_mul_f32 v8, 0x3b124925, v8
    v_lshlrev_b32 v9, 2, v15
    v_add_u32 v9, s52, v9
    v_cmp_eq_u32 vcc, 0, v9
    v_cvt_f32_u32 v9, v9
    v_mul_f32 v9, v8, v9
    v_mul_f32 v11, 0x42000000, v8
    v_fmamk_f32 v32, v8, 0x00000000, v9
    v_fmamk_f32 v33, v8, 0x40000000, v9
    v_fmamk_f32 v34, v8, 0x41000000, v9
    v_fmamk_f32 v35, v8, 0x41200000, v9
    v_fmamk_f32 v36, v8, 0x41800000, v9
    v_fmamk_f32 v37, v8, 0x41900000, v9
    v_fmamk_f32 v38, v8, 0x41c00000, v9
    v_fmamk_f32 v39, v8, 0x41d00000, v9
    v_cos_f32 v10, v11
    v_sin_f32 v12, v11
    v_cos_f32 v16, v32
    v_sin_f32 v24, v32
    v_cos_f32 v17, v33
    v_sin_f32 v25, v33
    v_cos_f32 v18, v34
    v_sin_f32 v26, v34
    v_cos_f32 v19, v35
    v_sin_f32 v27, v35
    v_cos_f32 v20, v36
    v_sin_f32 v28, v36
    v_cos_f32 v21, v37
    v_sin_f32 v29, v37
    v_cos_f32 v22, v38
    v_sin_f32 v30, v38
    v_cos_f32 v23, v39
    v_sin_f32 v31, v39
    v_mov_b32 v11, v10
    v_mov_b32 v13, v12
    v_cvt_pk_bf16_f32 v192, v16, v17
    v_cvt_pk_bf16_f32 v193, v18, v19
    v_cvt_pk_bf16_f32 v194, v20, v21
    v_cvt_pk_bf16_f32 v195, v22, v23
    v_cvt_pk_bf16_f32 v196, -v24, -v25
    v_cvt_pk_bf16_f32 v197, -v26, -v27
    v_cvt_pk_bf16_f32 v198, -v28, -v29
    v_cvt_pk_bf16_f32 v199, -v30, -v31
    v_pk_mul_f32 v[32:33], v[24:25], v[12:13]
    v_pk_mul_f32 v[34:35], v[26:27], v[12:13]
    v_pk_mul_f32 v[36:37], v[28:29], v[12:13]
    v_pk_mul_f32 v[38:39], v[30:31], v[12:13]
    v_pk_mul_f32 v[24:25], v[24:25], v[10:11]
    v_pk_mul_f32 v[26:27], v[26:27], v[10:11]
    v_pk_mul_f32 v[28:29], v[28:29], v[10:11]
    v_pk_mul_f32 v[30:31], v[30:31], v[10:11]
    v_pk_fma_f32 v[24:25], v[16:17], v[12:13], v[24:25]
    v_pk_fma_f32 v[26:27], v[18:19], v[12:13], v[26:27]
    v_pk_fma_f32 v[28:29], v[20:21], v[12:13], v[28:29]
    v_pk_fma_f32 v[30:31], v[22:23], v[12:13], v[30:31]
    v_pk_fma_f32 v[16:17], v[16:17], v[10:11], v[32:33] neg_lo:[0,0,1] neg_hi:[0,0,1]
    v_pk_fma_f32 v[18:19], v[18:19], v[10:11], v[34:35] neg_lo:[0,0,1] neg_hi:[0,0,1]
    v_pk_fma_f32 v[20:21], v[20:21], v[10:11], v[36:37] neg_lo:[0,0,1] neg_hi:[0,0,1]
    v_pk_fma_f32 v[22:23], v[22:23], v[10:11], v[38:39] neg_lo:[0,0,1] neg_hi:[0,0,1]
    v_cvt_pk_bf16_f32 v200, v16, v17
    v_cvt_pk_bf16_f32 v201, v18, v19
    v_cvt_pk_bf16_f32 v202, v20, v21
    v_cvt_pk_bf16_f32 v203, v22, v23
    v_cvt_pk_bf16_f32 v204, -v24, -v25
    v_cvt_pk_bf16_f32 v205, -v26, -v27
    v_cvt_pk_bf16_f32 v206, -v28, -v29
    v_cvt_pk_bf16_f32 v207, -v30, -v31
    v_pk_mul_f32 v[32:33], v[24:25], v[12:13]
    v_pk_mul_f32 v[34:35], v[26:27], v[12:13]
    v_pk_mul_f32 v[36:37], v[28:29], v[12:13]
    v_pk_mul_f32 v[38:39], v[30:31], v[12:13]
    v_pk_mul_f32 v[24:25], v[24:25], v[10:11]
    v_pk_mul_f32 v[26:27], v[26:27], v[10:11]
    v_pk_mul_f32 v[28:29], v[28:29], v[10:11]
    v_pk_mul_f32 v[30:31], v[30:31], v[10:11]
    v_pk_fma_f32 v[24:25], v[16:17], v[12:13], v[24:25]
    v_pk_fma_f32 v[26:27], v[18:19], v[12:13], v[26:27]
    v_pk_fma_f32 v[28:29], v[20:21], v[12:13], v[28:29]
    v_pk_fma_f32 v[30:31], v[22:23], v[12:13], v[30:31]
    v_pk_fma_f32 v[16:17], v[16:17], v[10:11], v[32:33] neg_lo:[0,0,1] neg_hi:[0,0,1]
    v_pk_fma_f32 v[18:19], v[18:19], v[10:11], v[34:35] neg_lo:[0,0,1] neg_hi:[0,0,1]
    v_pk_fma_f32 v[20:21], v[20:21], v[10:11], v[36:37] neg_lo:[0,0,1] neg_hi:[0,0,1]
    v_pk_fma_f32 v[22:23], v[22:23], v[10:11], v[38:39] neg_lo:[0,0,1] neg_hi:[0,0,1]
    v_cvt_pk_bf16_f32 v208, v16, v17
    v_cvt_pk_bf16_f32 v209, v18, v19
    v_cvt_pk_bf16_f32 v210, v20, v21
    v_cvt_pk_bf16_f32 v211, v22, v23
    v_cvt_pk_bf16_f32 v212, -v24, -v25
    v_cvt_pk_bf16_f32 v213, -v26, -v27
    v_cvt_pk_bf16_f32 v214, -v28, -v29
    v_cvt_pk_bf16_f32 v215, -v30, -v31
    v_pk_mul_f32 v[32:33], v[24:25], v[12:13]
    v_pk_mul_f32 v[34:35], v[26:27], v[12:13]
    v_pk_mul_f32 v[36:37], v[28:29], v[12:13]
    v_pk_mul_f32 v[38:39], v[30:31], v[12:13]
    v_pk_mul_f32 v[24:25], v[24:25], v[10:11]
    v_pk_mul_f32 v[26:27], v[26:27], v[10:11]
    v_pk_mul_f32 v[28:29], v[28:29], v[10:11]
    v_pk_mul_f32 v[30:31], v[30:31], v[10:11]
    v_pk_fma_f32 v[24:25], v[16:17], v[12:13], v[24:25]
    v_pk_fma_f32 v[26:27], v[18:19], v[12:13], v[26:27]
    v_pk_fma_f32 v[28:29], v[20:21], v[12:13], v[28:29]
    v_pk_fma_f32 v[30:31], v[22:23], v[12:13], v[30:31]
    v_pk_fma_f32 v[16:17], v[16:17], v[10:11], v[32:33] neg_lo:[0,0,1] neg_hi:[0,0,1]
    v_pk_fma_f32 v[18:19], v[18:19], v[10:11], v[34:35] neg_lo:[0,0,1] neg_hi:[0,0,1]
    v_pk_fma_f32 v[20:21], v[20:21], v[10:11], v[36:37] neg_lo:[0,0,1] neg_hi:[0,0,1]
    v_pk_fma_f32 v[22:23], v[22:23], v[10:11], v[38:39] neg_lo:[0,0,1] neg_hi:[0,0,1]
    v_cvt_pk_bf16_f32 v216, v16, v17
    v_cvt_pk_bf16_f32 v217, v18, v19
    v_cvt_pk_bf16_f32 v218, v20, v21
    v_cvt_pk_bf16_f32 v219, v22, v23
    v_cvt_pk_bf16_f32 v220, -v24, -v25
    v_cvt_pk_bf16_f32 v221, -v26, -v27
    v_cvt_pk_bf16_f32 v222, -v28, -v29
    v_cvt_pk_bf16_f32 v223, -v30, -v31
    v_pk_mul_f32 v[32:33], v[24:25], v[12:13]
    v_pk_mul_f32 v[34:35], v[26:27], v[12:13]
    v_pk_mul_f32 v[36:37], v[28:29], v[12:13]
    v_pk_mul_f32 v[38:39], v[30:31], v[12:13]
    v_pk_mul_f32 v[24:25], v[24:25], v[10:11]
    v_pk_mul_f32 v[26:27], v[26:27], v[10:11]
    v_pk_mul_f32 v[28:29], v[28:29], v[10:11]
    v_pk_mul_f32 v[30:31], v[30:31], v[10:11]
    v_pk_fma_f32 v[24:25], v[16:17], v[12:13], v[24:25]
    v_pk_fma_f32 v[26:27], v[18:19], v[12:13], v[26:27]
    v_pk_fma_f32 v[28:29], v[20:21], v[12:13], v[28:29]
    v_pk_fma_f32 v[30:31], v[22:23], v[12:13], v[30:31]
    v_pk_fma_f32 v[16:17], v[16:17], v[10:11], v[32:33] neg_lo:[0,0,1] neg_hi:[0,0,1]
    v_pk_fma_f32 v[18:19], v[18:19], v[10:11], v[34:35] neg_lo:[0,0,1] neg_hi:[0,0,1]
    v_pk_fma_f32 v[20:21], v[20:21], v[10:11], v[36:37] neg_lo:[0,0,1] neg_hi:[0,0,1]
    v_pk_fma_f32 v[22:23], v[22:23], v[10:11], v[38:39] neg_lo:[0,0,1] neg_hi:[0,0,1]
    v_cvt_pk_bf16_f32 v224, v16, v17
    v_cvt_pk_bf16_f32 v225, v18, v19
    v_cvt_pk_bf16_f32 v226, v20, v21
    v_cvt_pk_bf16_f32 v227, v22, v23
    v_cvt_pk_bf16_f32 v228, -v24, -v25
    v_cvt_pk_bf16_f32 v229, -v26, -v27
    v_cvt_pk_bf16_f32 v230, -v28, -v29
    v_cvt_pk_bf16_f32 v231, -v30, -v31
    v_pk_mul_f32 v[32:33], v[24:25], v[12:13]
    v_pk_mul_f32 v[34:35], v[26:27], v[12:13]
    v_pk_mul_f32 v[36:37], v[28:29], v[12:13]
    v_pk_mul_f32 v[38:39], v[30:31], v[12:13]
    v_pk_mul_f32 v[24:25], v[24:25], v[10:11]
    v_pk_mul_f32 v[26:27], v[26:27], v[10:11]
    v_pk_mul_f32 v[28:29], v[28:29], v[10:11]
    v_pk_mul_f32 v[30:31], v[30:31], v[10:11]
    v_pk_fma_f32 v[24:25], v[16:17], v[12:13], v[24:25]
    v_pk_fma_f32 v[26:27], v[18:19], v[12:13], v[26:27]
    v_pk_fma_f32 v[28:29], v[20:21], v[12:13], v[28:29]
    v_pk_fma_f32 v[30:31], v[22:23], v[12:13], v[30:31]
    v_pk_fma_f32 v[16:17], v[16:17], v[10:11], v[32:33] neg_lo:[0,0,1] neg_hi:[0,0,1]
    v_pk_fma_f32 v[18:19], v[18:19], v[10:11], v[34:35] neg_lo:[0,0,1] neg_hi:[0,0,1]
    v_pk_fma_f32 v[20:21], v[20:21], v[10:11], v[36:37] neg_lo:[0,0,1] neg_hi:[0,0,1]
    v_pk_fma_f32 v[22:23], v[22:23], v[10:11], v[38:39] neg_lo:[0,0,1] neg_hi:[0,0,1]
    v_cvt_pk_bf16_f32 v232, v16, v17
    v_cvt_pk_bf16_f32 v233, v18, v19
    v_cvt_pk_bf16_f32 v234, v20, v21
    v_cvt_pk_bf16_f32 v235, v22, v23
    v_cvt_pk_bf16_f32 v236, -v24, -v25
    v_cvt_pk_bf16_f32 v237, -v26, -v27
    v_cvt_pk_bf16_f32 v238, -v28, -v29
    v_cvt_pk_bf16_f32 v239, -v30, -v31
    v_pk_mul_f32 v[32:33], v[24:25], v[12:13]
    v_pk_mul_f32 v[34:35], v[26:27], v[12:13]
    v_pk_mul_f32 v[36:37], v[28:29], v[12:13]
    v_pk_mul_f32 v[38:39], v[30:31], v[12:13]
    v_pk_mul_f32 v[24:25], v[24:25], v[10:11]
    v_pk_mul_f32 v[26:27], v[26:27], v[10:11]
    v_pk_mul_f32 v[28:29], v[28:29], v[10:11]
    v_pk_mul_f32 v[30:31], v[30:31], v[10:11]
    v_pk_fma_f32 v[24:25], v[16:17], v[12:13], v[24:25]
    v_pk_fma_f32 v[26:27], v[18:19], v[12:13], v[26:27]
    v_pk_fma_f32 v[28:29], v[20:21], v[12:13], v[28:29]
    v_pk_fma_f32 v[30:31], v[22:23], v[12:13], v[30:31]
    v_pk_fma_f32 v[16:17], v[16:17], v[10:11], v[32:33] neg_lo:[0,0,1] neg_hi:[0,0,1]
    v_pk_fma_f32 v[18:19], v[18:19], v[10:11], v[34:35] neg_lo:[0,0,1] neg_hi:[0,0,1]
    v_pk_fma_f32 v[20:21], v[20:21], v[10:11], v[36:37] neg_lo:[0,0,1] neg_hi:[0,0,1]
    v_pk_fma_f32 v[22:23], v[22:23], v[10:11], v[38:39] neg_lo:[0,0,1] neg_hi:[0,0,1]
    v_cvt_pk_bf16_f32 v240, v16, v17
    v_cvt_pk_bf16_f32 v241, v18, v19
    v_cvt_pk_bf16_f32 v242, v20, v21
    v_cvt_pk_bf16_f32 v243, v22, v23
    v_cvt_pk_bf16_f32 v244, -v24, -v25
    v_cvt_pk_bf16_f32 v245, -v26, -v27
    v_cvt_pk_bf16_f32 v246, -v28, -v29
    v_cvt_pk_bf16_f32 v247, -v30, -v31
    v_and_b32 v8, 0xffff0000, v192
    v_or_b32 v8, 0x3f00, v8
    v_and_b32 v10, 1, v14
    v_lshlrev_b32 v10, 15, v10
    v_cndmask_b32 v192, v192, v8, vcc
    v_and_b32 v8, 0xffff, v8
    v_and_b32 v9, 0xffff0000, v196
    v_or3_b32 v9, v9, v10, v8
    v_cndmask_b32 v196, v196, v9, vcc
    s_cmp_lt_u32 s7, 11
    s_cbranch_scc1 L_help2
    s_lshl_b32 s41, s6, 2
    s_add_u32 s41, s41, s3
    v_lshlrev_b32 v9, 8, v15
    v_add_u32 v9, s41, v9
    v_mul_u32_u24 v9, v14, v9
    v_cvt_f32_u32 v9, v9
    v_mul_f32 v9, 0x3a000000, v9
    v_cvt_f32_u32 v8, v14
    v_mul_f32 v8, 0x3d000000, v8
    v_mov_b32 v5, v61
    s_waitcnt vmcnt(0)
    v_mul_f32 v11, 0x41800000, v8
    v_fmamk_f32 v32, v8, 0x00000000, v9
    v_fmamk_f32 v33, v8, 0x3f800000, v9
    v_fmamk_f32 v34, v8, 0x40000000, v9
    v_fmamk_f32 v35, v8, 0x40400000, v9
    v_fmamk_f32 v36, v8, 0x41000000, v9
    v_fmamk_f32 v37, v8, 0x41100000, v9
    v_fmamk_f32 v38, v8, 0x41200000, v9
    v_fmamk_f32 v39, v8, 0x41300000, v9
    v_cos_f32 v10, v11
    v_sin_f32 v12, v11
    v_cos_f32 v16, v32
    v_sin_f32 v24, v32
    v_cos_f32 v17, v33
    v_sin_f32 v25, v33
    v_cos_f32 v18, v34
    v_sin_f32 v26, v34
    v_cos_f32 v19, v35
    v_sin_f32 v27, v35
    v_cos_f32 v20, v36
    v_sin_f32 v28, v36
    v_cos_f32 v21, v37
    v_sin_f32 v29, v37
    v_cos_f32 v22, v38
    v_sin_f32 v30, v38
    v_cos_f32 v23, v39
    v_sin_f32 v31, v39
    v_mov_b32 v11, v10
    v_mov_b32 v13, v12
    v_cvt_pk_bf16_f32 v56, v16, v17
    v_cvt_pk_bf16_f32 v57, v18, v19
    v_cvt_pk_bf16_f32 v58, v20, v21
    v_cvt_pk_bf16_f32 v59, v22, v23
    v_cvt_pk_bf16_f32 v248, -v24, -v25
    v_cvt_pk_bf16_f32 v249, -v26, -v27
    v_cvt_pk_bf16_f32 v250, -v28, -v29
    v_cvt_pk_bf16_f32 v251, -v30, -v31
    v_pk_mul_f32 v[32:33], v[24:25], v[12:13]
    v_pk_mul_f32 v[34:35], v[26:27], v[12:13]
    v_pk_mul_f32 v[36:37], v[28:29], v[12:13]
    v_pk_mul_f32 v[38:39], v[30:31], v[12:13]
    v_pk_mul_f32 v[24:25], v[24:25], v[10:11]
    v_pk_mul_f32 v[26:27], v[26:27], v[10:11]
    v_pk_mul_f32 v[28:29], v[28:29], v[10:11]
    v_pk_mul_f32 v[30:31], v[30:31], v[10:11]
    v_pk_fma_f32 v[24:25], v[16:17], v[12:13], v[24:25]
    v_pk_fma_f32 v[26:27], v[18:19], v[12:13], v[26:27]
    v_pk_fma_f32 v[28:29], v[20:21], v[12:13], v[28:29]
    v_pk_fma_f32 v[30:31], v[22:23], v[12:13], v[30:31]
    v_pk_fma_f32 v[16:17], v[16:17], v[10:11], v[32:33] neg_lo:[0,0,1] neg_hi:[0,0,1]
    v_pk_fma_f32 v[18:19], v[18:19], v[10:11], v[34:35] neg_lo:[0,0,1] neg_hi:[0,0,1]
    v_pk_fma_f32 v[20:21], v[20:21], v[10:11], v[36:37] neg_lo:[0,0,1] neg_hi:[0,0,1]
    v_pk_fma_f32 v[22:23], v[22:23], v[10:11], v[38:39] neg_lo:[0,0,1] neg_hi:[0,0,1]
    v_cvt_pk_bf16_f32 v60, v16, v17
    v_cvt_pk_bf16_f32 v61, v18, v19
    v_cvt_pk_bf16_f32 v62, v20, v21
    v_cvt_pk_bf16_f32 v63, v22, v23
    v_cvt_pk_bf16_f32 v252, -v24, -v25
    v_cvt_pk_bf16_f32 v253, -v26, -v27
    v_cvt_pk_bf16_f32 v254, -v28, -v29
    v_cvt_pk_bf16_f32 v255, -v30, -v31
    v_lshrrev_b32 v49, 1, v14
    v_and_b32 v49, 7, v49
    v_xor_b32 v49, v49, v15
    v_lshlrev_b32 v49, 4, v49
    v_lshl_or_b32 v6, v14, 7, v49
    s_lshl_b32 s43, s3, 12
    v_add_u32 v6, s43, v6
    v_and_b32 v3, 2, v14
    v_lshlrev_b32 v3, 30, v3
    v_or_b32 v3, 1.0, v3
    v_mov_b32 v2, v3
    v_lshlrev_b32 v4, 4, v0
    s_mul_i32 s99, s41, 30720
    s_mul_i32 s42, s5, 6144
    s_add_u32 s99, s99, s42
    s_add_u32 s99, s99, 6619136
    s_add_u32 s100, s99, 2048
    s_add_u32 s101, s99, 4096
    s_mul_i32 s27, s26, 8256
    s_and_b32 s43, s27, 0x1c040
    s_add_u32 s44, s27, 57792
    s_and_b32 s44, s44, 0x1c040
    s_lshr_b32 s46, s27, 2
    s_and_b32 s46, s46, 0x7800
    v_xor_b32 v8, s43, v6
    v_xor_b32 v10, s44, v6
    v_xor_b32 v9, 32, v8
    v_xor_b32 v11, 32, v10
    v_add_u32 v12, s46, v5
    s_waitcnt lgkmcnt(0)
    s_add_u32 s62, s62, 2654435769
    s_cmp_lg_u32 s3, 3
    s_cbranch_scc1 pw_23
    s_sub_u32 s60, s62, 2654435769
    s_lshl_b32 s61, s7, 4
    s_add_u32 s61, s61, s6
    s_lshl_b32 s61, s61, 7
    s_add_u32 s61, s61, 65536
    v_lshrrev_b32 v12, 3, v0
    v_mul_u32_u24 v12, 32768, v12
    v_and_b32 v13, 7, v0
    v_lshl_add_u32 v12, v13, 4, v12
    v_mov_b32 v40, s60
    v_mov_b32 v41, s60
    v_mov_b32 v42, s60
    v_mov_b32 v43, s60
    buffer_store_dwordx4 v[40:43], v12, s[36:39], s61 offen sc1
pw_23:
    v_add_u32 v12, s46, v5
    s_barrier
    ds_read_b128 v[16:19], v8
    ds_read_b128 v[24:27], v12 offset:0
    ds_read_b128 v[28:31], v12 offset:14336
    ds_read_b128 v[32:35], v12 offset:28672
    ds_read_b128 v[20:23], v10
    s_waitcnt lgkmcnt(3)
    v_mfma_f32_32x32x16_bf16 v[64:79], v[16:19], v[24:27], 0
    ds_read_b128 v[36:39], v9
    ds_read_b128 v[44:47], v12 offset:1024
    s_waitcnt lgkmcnt(4)
    v_mfma_f32_32x32x16_bf16 v[96:111], v[16:19], v[28:31], 0
    ds_read_b128 v[48:51], v12 offset:15360
    s_add_u32 s27, s27, 8256
    s_cmp_eq_u32 s27, 57792
    s_cselect_b32 s27, 0, s27
    s_waitcnt lgkmcnt(4)
    v_mfma_f32_32x32x16_bf16 v[128:143], v[16:19], v[32:35], 0
    ds_read_b128 v[52:55], v12 offset:29696
    s_and_b32 s43, s27, 0x1c040
    s_add_u32 s44, s27, 57792
    s_and_b32 s44, s44, 0x1c040
    s_waitcnt lgkmcnt(4)
    v_mfma_f32_32x32x16_bf16 v[80:95], v[20:23], v[24:27], 0
    ds_read_b128 v[40:43], v11
    s_lshr_b32 s46, s27, 2
    s_and_b32 s46, s46, 0x7800
    v_mfma_f32_32x32x16_bf16 v[112:127], v[20:23], v[28:31], 0
    v_xor_b32 v8, s43, v6
    v_xor_b32 v10, s44, v6
    v_xor_b32 v9, 32, v8
    v_xor_b32 v11, 32, v10
    v_add_u32 v12, s46, v5
    v_mfma_f32_32x32x16_bf16 v[144:159], v[20:23], v[32:35], 0
    s_barrier
    s_waitcnt lgkmcnt(3)
    v_mfma_f32_32x32x16_bf16 v[64:79], v[36:39], v[44:47], v[64:79]
    ds_read_b128 v[16:19], v8
    ds_read_b128 v[24:27], v12 offset:0
    s_waitcnt lgkmcnt(4)
    v_mfma_f32_32x32x16_bf16 v[96:111], v[36:39], v[48:51], v[96:111]
    ds_read_b128 v[28:31], v12 offset:14336
    s_waitcnt lgkmcnt(4)
    v_mfma_f32_32x32x16_bf16 v[128:143], v[36:39], v[52:55], v[128:143]
    ds_read_b128 v[32:35], v12 offset:28672
    s_waitcnt lgkmcnt(4)
    v_mfma_f32_32x32x16_bf16 v[80:95], v[40:43], v[44:47], v[80:95]
    ds_read_b128 v[20:23], v10
    v_mfma_f32_32x32x16_bf16 v[112:127], v[40:43], v[48:51], v[112:127]
    v_mfma_f32_32x32x16_bf16 v[144:159], v[40:43], v[52:55], v[144:159]
    s_mov_b32 s45, 1
a1loop_20:
    s_waitcnt lgkmcnt(3)
    v_mfma_f32_32x32x16_bf16 v[64:79], v[16:19], v[24:27], v[64:79]
    ds_read_b128 v[36:39], v9
    ds_read_b128 v[44:47], v12 offset:1024
    s_waitcnt lgkmcnt(4)
    v_mfma_f32_32x32x16_bf16 v[96:111], v[16:19], v[28:31], v[96:111]
    ds_read_b128 v[48:51], v12 offset:15360
    s_add_u32 s27, s27, 8256
    s_cmp_eq_u32 s27, 57792
    s_cselect_b32 s27, 0, s27
    s_waitcnt lgkmcnt(4)
    v_mfma_f32_32x32x16_bf16 v[128:143], v[16:19], v[32:35], v[128:143]
    ds_read_b128 v[52:55], v12 offset:29696
    s_and_b32 s43, s27, 0x1c040
    s_add_u32 s44, s27, 57792
    s_and_b32 s44, s44, 0x1c040
    s_waitcnt lgkmcnt(4)
    v_mfma_f32_32x32x16_bf16 v[80:95], v[20:23], v[24:27], v[80:95]
    ds_read_b128 v[40:43], v11
    s_lshr_b32 s46, s27, 2
    s_and_b32 s46, s46, 0x7800
    v_mfma_f32_32x32x16_bf16 v[112:127], v[20:23], v[28:31], v[112:127]
    v_xor_b32 v8, s43, v6
    v_xor_b32 v10, s44, v6
    v_xor_b32 v9, 32, v8
    v_xor_b32 v11, 32, v10
    v_add_u32 v12, s46, v5
    v_mfma_f32_32x32x16_bf16 v[144:159], v[20:23], v[32:35], v[144:159]
    s_add_u32 s45, s45, 1
    s_cmp_eq_u32 s45, 7
    s_cbranch_scc1 a1last_21
    s_nop 0
    s_cmp_eq_u32 s45, 6
    s_cbranch_scc1 a1nb_22
    s_barrier
a1nb_22:
    s_waitcnt lgkmcnt(3)
    v_mfma_f32_32x32x16_bf16 v[64:79], v[36:39], v[44:47], v[64:79]
    ds_read_b128 v[16:19], v8
    ds_read_b128 v[24:27], v12 offset:0
    s_waitcnt lgkmcnt(4)
    v_mfma_f32_32x32x16_bf16 v[96:111], v[36:39], v[48:51], v[96:111]
    ds_read_b128 v[28:31], v12 offset:14336
    s_waitcnt lgkmcnt(4)
    v_mfma_f32_32x32x16_bf16 v[128:143], v[36:39], v[52:55], v[128:143]
    ds_read_b128 v[32:35], v12 offset:28672
    s_waitcnt lgkmcnt(4)
    v_mfma_f32_32x32x16_bf16 v[80:95], v[40:43], v[44:47], v[80:95]
    ds_read_b128 v[20:23], v10
    v_mfma_f32_32x32x16_bf16 v[112:127], v[40:43], v[48:51], v[112:127]
    v_mfma_f32_32x32x16_bf16 v[144:159], v[40:43], v[52:55], v[144:159]
    s_branch a1loop_20
a1last_21:
    s_waitcnt lgkmcnt(3)
    v_mfma_f32_32x32x16_bf16 v[64:79], v[36:39], v[44:47], v[64:79]
    s_waitcnt lgkmcnt(0)
    v_mfma_f32_32x32x16_bf16 v[80:95], v[40:43], v[44:47], v[80:95]
    v_mfma_f32_32x32x16_bf16 v[96:111], v[36:39], v[48:51], v[96:111]
    v_mfma_f32_32x32x16_bf16 v[112:127], v[40:43], v[48:51], v[112:127]
    v_mfma_f32_32x32x16_bf16 v[128:143], v[36:39], v[52:55], v[128:143]
    v_mfma_f32_32x32x16_bf16 v[144:159], v[40:43], v[52:55], v[144:159]
    v_mov_b32 v12, 163068
    v_mov_b32 v13, 1
    s_mov_b64 exec, 1
    ds_add_u32 v12, v13
    s_mov_b64 exec, -1
    s_nop 2
    v_fmac_f32 v64, v3, v80
    v_fmac_f32 v65, v3, v81
    v_cvt_pk_bf16_f32 v16, v64, v65
    v_fmac_f32 v66, v3, v82
    v_fmac_f32 v67, v3, v83
    v_cvt_pk_bf16_f32 v17, v66, v67
    v_fmac_f32 v68, v3, v84
    v_fmac_f32 v69, v3, v85
    v_cvt_pk_bf16_f32 v18, v68, v69
    v_fmac_f32 v70, v3, v86
    v_fmac_f32 v71, v3, v87
    v_cvt_pk_bf16_f32 v19, v70, v71
    v_fmac_f32 v72, v3, v88
    v_fmac_f32 v73, v3, v89
    v_cvt_pk_bf16_f32 v20, v72, v73
    v_fmac_f32 v74, v3, v90
    v_fmac_f32 v75, v3, v91
    v_cvt_pk_bf16_f32 v21, v74, v75
    v_fmac_f32 v76, v3, v92
    v_fmac_f32 v77, v3, v93
    v_cvt_pk_bf16_f32 v22, v76, v77
    v_fmac_f32 v78, v3, v94
    v_fmac_f32 v79, v3, v95
    v_cvt_pk_bf16_f32 v23, v78, v79
    v_mfma_f32_32x32x16_bf16 v[64:79], v[16:19], v[56:59], 0
    v_fmac_f32 v96, v3, v112
    v_fmac_f32 v97, v3, v113
    v_cvt_pk_bf16_f32 v24, v96, v97
    v_fmac_f32 v98, v3, v114
    v_fmac_f32 v99, v3, v115
    v_cvt_pk_bf16_f32 v25, v98, v99
    v_mfma_f32_32x32x16_bf16 v[80:95], v[16:19], v[248:251], 0
    v_fmac_f32 v100, v3, v116
    v_fmac_f32 v101, v3, v117
    v_cvt_pk_bf16_f32 v26, v100, v101
    v_fmac_f32 v102, v3, v118
    v_fmac_f32 v103, v3, v119
    v_cvt_pk_bf16_f32 v27, v102, v103
    v_mfma_f32_32x32x16_bf16 v[64:79], v[20:23], v[60:63], v[64:79]
    v_fmac_f32 v104, v3, v120
    v_fmac_f32 v105, v3, v121
    v_cvt_pk_bf16_f32 v28, v104, v105
    v_fmac_f32 v106, v3, v122
    v_fmac_f32 v107, v3, v123
    v_cvt_pk_bf16_f32 v29, v106, v107
    v_mfma_f32_32x32x16_bf16 v[80:95], v[20:23], v[252:255], v[80:95]
    v_fmac_f32 v108, v3, v124
    v_fmac_f32 v109, v3, v125
    v_cvt_pk_bf16_f32 v30, v108, v109
    v_fmac_f32 v110, v3, v126
    v_fmac_f32 v111, v3, v127
    v_cvt_pk_bf16_f32 v31, v110, v111
    v_mfma_f32_32x32x16_bf16 v[96:111], v[24:27], v[56:59], 0
    v_fmac_f32 v128, v3, v144
    v_fmac_f32 v129, v3, v145
    v_cvt_pk_bf16_f32 v32, v128, v129
    v_fmac_f32 v130, v3, v146
    v_fmac_f32 v131, v3, v147
    v_cvt_pk_bf16_f32 v33, v130, v131
    v_mfma_f32_32x32x16_bf16 v[112:127], v[24:27], v[248:251], 0
    v_fmac_f32 v132, v3, v148
    v_fmac_f32 v133, v3, v149
    v_cvt_pk_bf16_f32 v34, v132, v133
    v_fmac_f32 v134, v3, v150
    v_fmac_f32 v135, v3, v151
    v_cvt_pk_bf16_f32 v35, v134, v135
    v_mfma_f32_32x32x16_bf16 v[96:111], v[28:31], v[60:63], v[96:111]
    v_fmac_f32 v136, v3, v152
    v_fmac_f32 v137, v3, v153
    v_cvt_pk_bf16_f32 v36, v136, v137
    v_fmac_f32 v138, v3, v154
    v_fmac_f32 v139, v3, v155
    v_cvt_pk_bf16_f32 v37, v138, v139
    v_mfma_f32_32x32x16_bf16 v[112:127], v[28:31], v[252:255], v[112:127]
    v_fmac_f32 v140, v3, v156
    v_fmac_f32 v141, v3, v157
    v_cvt_pk_bf16_f32 v38, v140, v141
    v_fmac_f32 v142, v3, v158
    v_fmac_f32 v143, v3, v159
    v_cvt_pk_bf16_f32 v39, v142, v143
    v_mfma_f32_32x32x16_bf16 v[128:143], v[32:35], v[56:59], 0
    v_sub_f32 v64, v64, v81
    v_add_f32 v80, v80, v65
    v_cvt_pk_bf16_f32 v40, v64, v80
    v_sub_f32 v66, v66, v83
    v_add_f32 v82, v82, v67
    v_cvt_pk_bf16_f32 v41, v66, v82
    v_sub_f32 v68, v68, v85
    v_mfma_f32_32x32x16_bf16 v[144:159], v[32:35], v[248:251], 0
    v_add_f32 v84, v84, v69
    v_cvt_pk_bf16_f32 v42, v68, v84
    v_sub_f32 v70, v70, v87
    v_add_f32 v86, v86, v71
    v_cvt_pk_bf16_f32 v43, v70, v86
    buffer_store_dwordx4 v[40:43], v4, s[36:39], s99 offen offset:0 sc1
    v_sub_f32 v72, v72, v89
    v_mfma_f32_32x32x16_bf16 v[128:143], v[36:39], v[60:63], v[128:143]
    v_add_f32 v88, v88, v73
    v_cvt_pk_bf16_f32 v44, v72, v88
    v_sub_f32 v74, v74, v91
    v_add_f32 v90, v90, v75
    v_cvt_pk_bf16_f32 v45, v74, v90
    v_sub_f32 v76, v76, v93
    v_add_f32 v92, v92, v77
    v_mfma_f32_32x32x16_bf16 v[144:159], v[36:39], v[252:255], v[144:159]
    v_cvt_pk_bf16_f32 v46, v76, v92
    v_sub_f32 v78, v78, v95
    v_add_f32 v94, v94, v79
    v_cvt_pk_bf16_f32 v47, v78, v94
    buffer_store_dwordx4 v[44:47], v4, s[36:39], s99 offen offset:1024 sc1
    v_sub_f32 v96, v96, v113
    v_add_f32 v112, v112, v97
    v_cvt_pk_bf16_f32 v48, v96, v112
    v_sub_f32 v98, v98, v115
    v_add_f32 v114, v114, v99
    v_cvt_pk_bf16_f32 v49, v98, v114
    v_sub_f32 v100, v100, v117
    v_add_f32 v116, v116, v101
    v_cvt_pk_bf16_f32 v50, v100, v116
    v_sub_f32 v102, v102, v119
    v_add_f32 v118, v118, v103
    v_cvt_pk_bf16_f32 v51, v102, v118
    buffer_store_dwordx4 v[48:51], v4, s[36:39], s100 offen offset:0 sc1
    v_sub_f32 v104, v104, v121
    v_add_f32 v120, v120, v105
    v_cvt_pk_bf16_f32 v52, v104, v120
    v_sub_f32 v106, v106, v123
    v_add_f32 v122, v122, v107
    v_cvt_pk_bf16_f32 v53, v106, v122
    v_sub_f32 v108, v108, v125
    v_add_f32 v124, v124, v109
    v_cvt_pk_bf16_f32 v54, v108, v124
    v_sub_f32 v110, v110, v127
    v_add_f32 v126, v126, v111
    v_cvt_pk_bf16_f32 v55, v110, v126
    buffer_store_dwordx4 v[52:55], v4, s[36:39], s100 offen offset:1024 sc1
    v_sub_f32 v128, v128, v145
    v_add_f32 v144, v144, v129
    v_cvt_pk_bf16_f32 v56, v128, v144
    v_sub_f32 v130, v130, v147
    v_add_f32 v146, v146, v131
    v_cvt_pk_bf16_f32 v57, v130, v146
    v_sub_f32 v132, v132, v149
    v_add_f32 v148, v148, v133
    v_cvt_pk_bf16_f32 v58, v132, v148
    v_sub_f32 v134, v134, v151
    v_add_f32 v150, v150, v135
    v_cvt_pk_bf16_f32 v59, v134, v150
    buffer_store_dwordx4 v[56:59], v4, s[36:39], s101 offen offset:0 sc1
    v_sub_f32 v136, v136, v153
    v_add_f32 v152, v152, v137
    v_cvt_pk_bf16_f32 v60, v136, v152
    v_sub_f32 v138, v138, v155
    v_add_f32 v154, v154, v139
    v_cvt_pk_bf16_f32 v61, v138, v154
    v_sub_f32 v140, v140, v157
    v_add_f32 v156, v156, v141
    v_cvt_pk_bf16_f32 v62, v140, v156
    v_sub_f32 v142, v142, v159
    v_add_f32 v158, v158, v143
    v_cvt_pk_bf16_f32 v63, v142, v158
    buffer_store_dwordx4 v[60:63], v4, s[36:39], s101 offen offset:1024 sc1
L_pub1:
    s_lshl_b32 s26, s7, 11
    s_lshl_b32 s42, s6, 7
    s_add_u32 s26, s26, s42
    s_add_u32 s26, s26, 65536
    v_lshrrev_b32 v10, 3, v0
    v_mul_u32_u24 v10, 32768, v10
    v_and_b32 v13, 7, v0
    v_lshl_add_u32 v10, v13, 4, v10
    v_mov_b32 v36, s62
    v_mov_b32 v37, s62
    v_mov_b32 v38, s62
    v_mov_b32 v39, s62
    v_mov_b32 v12, 162828
    v_mov_b32 v13, 1
    s_mov_b64 exec, 1
    s_waitcnt vmcnt(0)
    ds_add_rtn_u32 v13, v12, v13
    s_mov_b64 exec, -1
    s_waitcnt lgkmcnt(0)
    v_readfirstlane_b32 s60, v13
    s_nop 0
    s_cmp_lg_u32 s60, 3
    s_cbranch_scc1 pub_26
    buffer_store_dwordx4 v[36:39], v10, s[36:39], s26 offen sc1
    v_mov_b32 v12, 163116
    v_mov_b32 v13, 1
    s_mov_b64 exec, 1
    ds_add_u32 v12, v13
    s_mov_b64 exec, -1
pub_26:
nopub_25:
    v_lshrrev_b32 v8, 1, v14
    s_lshl_b32 s43, s40, 4
    v_add_u32 v8, s43, v8
    v_cvt_f32_u32 v8, v8
    v_mul_f32 v8, 0x3c800000, v8
    v_and_b32 v9, 1, v14
    v_cvt_f32_u32 v9, v9
    v_mul_f32 v9, 0x3e800000, v9
    v_lshlrev_b32 v10, 1, v15
    v_cvt_f32_u32 v10, v10
    v_fma_f32 v9, v8, v10, v9
    v_mul_f32 v11, 0x41000000, v8
    v_fmamk_f32 v32, v8, 0x00000000, v9
    v_fmamk_f32 v33, v8, 0x3f800000, v9
    v_fmamk_f32 v34, v8, 0x40800000, v9
    v_fmamk_f32 v35, v8, 0x40a00000, v9
    v_cos_f32 v10, v11
    v_sin_f32 v12, v11
    v_cos_f32 v16, v32
    v_sin_f32 v24, v32
    v_cos_f32 v17, v33
    v_sin_f32 v25, v33
    v_cos_f32 v18, v34
    v_sin_f32 v26, v34
    v_cos_f32 v19, v35
    v_sin_f32 v27, v35
    v_mov_b32 v11, v10
    v_mov_b32 v13, v12
    v_cvt_pk_bf16_f32 v128, v16, v24
    v_cvt_pk_bf16_f32 v129, v17, v25
    v_cvt_pk_bf16_f32 v130, v18, v26
    v_cvt_pk_bf16_f32 v131, v19, v27
    v_pk_mul_f32 v[32:33], v[24:25], v[12:13]
    v_pk_mul_f32 v[34:35], v[26:27], v[12:13]
    v_pk_mul_f32 v[24:25], v[24:25], v[10:11]
    v_pk_mul_f32 v[26:27], v[26:27], v[10:11]
    v_pk_fma_f32 v[24:25], v[16:17], v[12:13], v[24:25]
    v_pk_fma_f32 v[26:27], v[18:19], v[12:13], v[26:27]
    v_pk_fma_f32 v[16:17], v[16:17], v[10:11], v[32:33] neg_lo:[0,0,1] neg_hi:[0,0,1]
    v_pk_fma_f32 v[18:19], v[18:19], v[10:11], v[34:35] neg_lo:[0,0,1] neg_hi:[0,0,1]
    v_cvt_pk_bf16_f32 v132, v16, v24
    v_cvt_pk_bf16_f32 v133, v17, v25
    v_cvt_pk_bf16_f32 v134, v18, v26
    v_cvt_pk_bf16_f32 v135, v19, v27
    v_pk_mul_f32 v[32:33], v[24:25], v[12:13]
    v_pk_mul_f32 v[34:35], v[26:27], v[12:13]
    v_pk_mul_f32 v[24:25], v[24:25], v[10:11]
    v_pk_mul_f32 v[26:27], v[26:27], v[10:11]
    v_pk_fma_f32 v[24:25], v[16:17], v[12:13], v[24:25]
    v_pk_fma_f32 v[26:27], v[18:19], v[12:13], v[26:27]
    v_pk_fma_f32 v[16:17], v[16:17], v[10:11], v[32:33] neg_lo:[0,0,1] neg_hi:[0,0,1]
    v_pk_fma_f32 v[18:19], v[18:19], v[10:11], v[34:35] neg_lo:[0,0,1] neg_hi:[0,0,1]
    v_cvt_pk_bf16_f32 v136, v16, v24
    v_cvt_pk_bf16_f32 v137, v17, v25
    v_cvt_pk_bf16_f32 v138, v18, v26
    v_cvt_pk_bf16_f32 v139, v19, v27
    v_pk_mul_f32 v[32:33], v[24:25], v[12:13]
    v_pk_mul_f32 v[34:35], v[26:27], v[12:13]
    v_pk_mul_f32 v[24:25], v[24:25], v[10:11]
    v_pk_mul_f32 v[26:27], v[26:27], v[10:11]
    v_pk_fma_f32 v[24:25], v[16:17], v[12:13], v[24:25]
    v_pk_fma_f32 v[26:27], v[18:19], v[12:13], v[26:27]
    v_pk_fma_f32 v[16:17], v[16:17], v[10:11], v[32:33] neg_lo:[0,0,1] neg_hi:[0,0,1]
    v_pk_fma_f32 v[18:19], v[18:19], v[10:11], v[34:35] neg_lo:[0,0,1] neg_hi:[0,0,1]
    v_cvt_pk_bf16_f32 v140, v16, v24
    v_cvt_pk_bf16_f32 v141, v17, v25
    v_cvt_pk_bf16_f32 v142, v18, v26
    v_cvt_pk_bf16_f32 v143, v19, v27
    v_pk_mul_f32 v[32:33], v[24:25], v[12:13]
    v_pk_mul_f32 v[34:35], v[26:27], v[12:13]
    v_pk_mul_f32 v[24:25], v[24:25], v[10:11]
    v_pk_mul_f32 v[26:27], v[26:27], v[10:11]
    v_pk_fma_f32 v[24:25], v[16:17], v[12:13], v[24:25]
    v_pk_fma_f32 v[26:27], v[18:19], v[12:13], v[26:27]
    v_pk_fma_f32 v[16:17], v[16:17], v[10:11], v[32:33] neg_lo:[0,0,1] neg_hi:[0,0,1]
    v_pk_fma_f32 v[18:19], v[18:19], v[10:11], v[34:35] neg_lo:[0,0,1] neg_hi:[0,0,1]
    v_cvt_pk_bf16_f32 v144, v16, v24
    v_cvt_pk_bf16_f32 v145, v17, v25
    v_cvt_pk_bf16_f32 v146, v18, v26
    v_cvt_pk_bf16_f32 v147, v19, v27
    v_pk_mul_f32 v[32:33], v[24:25], v[12:13]
    v_pk_mul_f32 v[34:35], v[26:27], v[12:13]
    v_pk_mul_f32 v[24:25], v[24:25], v[10:11]
    v_pk_mul_f32 v[26:27], v[26:27], v[10:11]
    v_pk_fma_f32 v[24:25], v[16:17], v[12:13], v[24:25]
    v_pk_fma_f32 v[26:27], v[18:19], v[12:13], v[26:27]
    v_pk_fma_f32 v[16:17], v[16:17], v[10:11], v[32:33] neg_lo:[0,0,1] neg_hi:[0,0,1]
    v_pk_fma_f32 v[18:19], v[18:19], v[10:11], v[34:35] neg_lo:[0,0,1] neg_hi:[0,0,1]
    v_cvt_pk_bf16_f32 v148, v16, v24
    v_cvt_pk_bf16_f32 v149, v17, v25
    v_cvt_pk_bf16_f32 v150, v18, v26
    v_cvt_pk_bf16_f32 v151, v19, v27
    v_pk_mul_f32 v[32:33], v[24:25], v[12:13]
    v_pk_mul_f32 v[34:35], v[26:27], v[12:13]
    v_pk_mul_f32 v[24:25], v[24:25], v[10:11]
    v_pk_mul_f32 v[26:27], v[26:27], v[10:11]
    v_pk_fma_f32 v[24:25], v[16:17], v[12:13], v[24:25]
    v_pk_fma_f32 v[26:27], v[18:19], v[12:13], v[26:27]
    v_pk_fma_f32 v[16:17], v[16:17], v[10:11], v[32:33] neg_lo:[0,0,1] neg_hi:[0,0,1]
    v_pk_fma_f32 v[18:19], v[18:19], v[10:11], v[34:35] neg_lo:[0,0,1] neg_hi:[0,0,1]
    v_cvt_pk_bf16_f32 v152, v16, v24
    v_cvt_pk_bf16_f32 v153, v17, v25
    v_cvt_pk_bf16_f32 v154, v18, v26
    v_cvt_pk_bf16_f32 v155, v19, v27
    v_pk_mul_f32 v[32:33], v[24:25], v[12:13]
    v_pk_mul_f32 v[34:35], v[26:27], v[12:13]
    v_pk_mul_f32 v[24:25], v[24:25], v[10:11]
    v_pk_mul_f32 v[26:27], v[26:27], v[10:11]
    v_pk_fma_f32 v[24:25], v[16:17], v[12:13], v[24:25]
    v_pk_fma_f32 v[26:27], v[18:19], v[12:13], v[26:27]
    v_pk_fma_f32 v[16:17], v[16:17], v[10:11], v[32:33] neg_lo:[0,0,1] neg_hi:[0,0,1]
    v_pk_fma_f32 v[18:19], v[18:19], v[10:11], v[34:35] neg_lo:[0,0,1] neg_hi:[0,0,1]
    v_cvt_pk_bf16_f32 v156, v16, v24
    v_cvt_pk_bf16_f32 v157, v17, v25
    v_cvt_pk_bf16_f32 v158, v18, v26
    v_cvt_pk_bf16_f32 v159, v19, v27
    s_cmp_lt_u32 s7, 11
    s_cbranch_scc1 L_gen
L_help2:
    v_mov_b32 v253, 162816
    v_mov_b32 v254, 1
    s_mov_b32 s28, s10
    s_mov_b32 s29, s11
    s_mov_b32 s30, 921600
    s_mov_b32 s31, 0x00020000
    s_mov_b32 s56, s12
    s_mov_b32 s57, s13
    s_mov_b32 s58, 921600
    s_mov_b32 s59, 0x00020000
    s_lshr_b32 s54, s2, 3
    s_mul_i32 s55, s4, 1800
    s_mul_i32 s43, s40, 230400
    s_add_u32 s55, s55, s43
    s_lshl_b32 s43, s54, 4
    s_add_u32 s55, s55, s43
    s_cmp_lg_u32 s54, 28
    s_cbranch_scc1 nyq_29
    s_mov_b32 s28, s12
    s_mov_b32 s29, s13
    s_mov_b32 s30, 921600
    s_mov_b32 s31, 0x00020000
    s_mov_b32 s56, s10
    s_mov_b32 s57, s11
    s_mov_b32 s58, 921600
    s_mov_b32 s59, 0x00020000
    s_sub_u32 s55, s55, 14
nyq_29:
    v_lshrrev_b32 v9, 2, v0
    v_and_b32 v10, 3, v0
    v_lshl_add_u32 v9, v9, 5, v10
    v_mul_u32_u24 v248, 450, v9
    v_lshrrev_b32 v9, 4, v0
    v_and_b32 v8, 15, v0
    v_lshlrev_b32 v10, 2, v9
    v_xor_b32 v8, v8, v10
    v_lshlrev_b32 v8, 4, v8
    v_mul_u32_u24 v9, 896, v9
    v_add_u32 v250, v8, v9
    v_mul_u32_u24 v252, 3712, v15
    v_lshl_add_u32 v251, v14, 4, v252
    v_add_u32 v252, 3584, v252
    s_cmp_eq_u32 s40, 3
    s_cselect_b32 s42, 0, 16384
    v_mul_u32_u24 v255, s42, v15
    v_lshl_add_u32 v255, v14, 7, v255
    s_lshl_b32 s42, s40, 12
    v_add_u32 v255, s42, v255
    s_lshr_b32 s5, s2, 3
    v_lshrrev_b32 v8, 3, v0
    v_and_b32 v9, 4, v8
    v_bfe_u32 v10, v8, 1, 1
    v_or_b32 v9, v9, v10
    v_and_b32 v8, 1, v8
    v_lshl_or_b32 v9, v8, 1, v9
    v_mul_u32_u24 v1, 30720, v9
    v_bfe_u32 v8, v0, 2, 1
    v_lshl_add_u32 v1, v8, 9, v1
    v_and_b32 v8, 3, v0
    v_lshl_add_u32 v1, v8, 4, v1
    s_lshl_b32 s41, s5, 10
    s_lshl_b32 s42, s4, 6
    s_add_u32 s41, s41, s42
    s_add_u32 s41, s41, 6619136
    s_mul_i32 s42, s40, 491520
    s_add_u32 s41, s41, s42
    s_mul_i32 s44, s5, 43
    s_lshr_b32 s44, s44, 8
    s_lshl_b32 s45, s44, 11
    s_and_b32 s46, s2, 7
    s_lshl_b32 s46, s46, 15
    s_add_u32 s46, s46, 88064
    v_and_b32 v9, 15, v0
    v_lshlrev_b32 v9, 7, v9
    v_add_u32 v9, s45, v9
    s_lshl_b32 s43, s40, 11
    s_add_u32 m0, s43, 16384
    s_add_u32 s47, s41, 244736
    s_nop 0
    v_lshlrev_b32 v4, 4, v0
    s_cmp_eq_u32 s5, 28
    s_cselect_b32 s45, 14, 0
    v_and_b32 v8, 3, v14
    v_lshrrev_b32 v7, 2, v14
    v_lshl_add_u32 v2, v15, 3, v8
    v_lshlrev_b32 v2, 4, v2
    v_lshl_add_u32 v2, v7, 1, v2
    s_add_u32 s42, s43, s45
    s_add_u32 s42, s42, 24576
    v_add_u32 v2, s42, v2
    v_mul_u32_u24 v3, 59392, v15
    v_lshl_add_u32 v3, v7, 4, v3
    v_lshl_add_u32 v3, v8, 2, v3
    v_lshrrev_b32 v5, 2, v7
    v_lshl_add_u32 v5, v15, 1, v5
    v_lshl_add_u32 v5, v5, 2, v8
    v_and_b32 v10, 3, v7
    v_lshl_add_u32 v5, v5, 2, v10
    v_lshlrev_b32 v5, 2, v5
    v_add_u32 v5, 16384, v5
    v_add_u32 v8, 8192, v4
    v_add_u32 v7, s43, v8
    s_mul_i32 s53, s40, 475136
    s_mul_i32 s42, s4, 3712
    s_add_u32 s53, s53, s42
    s_lshl_b32 s42, s5, 7
    s_add_u32 s53, s53, s42
    s_add_u32 s53, s53, 8585216
    v_lshlrev_b32 v3, 2, v14
    v_lshl_add_u32 v3, v15, 8, v3
    s_add_u32 s42, s43, 24576
    v_add_u32 v3, s42, v3
    v_add_u32 v6, 1024, v3
    v_lshrrev_b32 v88, 3, v0
    v_mul_u32_u24 v88, 29696, v88
    v_and_b32 v10, 7, v0
    v_lshl_add_u32 v88, v10, 4, v88
    v_mov_b32 v64, 0
    v_mov_b32 v65, 0
    v_mov_b32 v66, 0
    v_mov_b32 v67, 0
    v_mov_b32 v68, 0
    v_mov_b32 v69, 0
    v_mov_b32 v70, 0
    v_mov_b32 v71, 0
    v_mov_b32 v72, 0
    v_mov_b32 v73, 0
    v_mov_b32 v74, 0
    v_mov_b32 v75, 0
    v_mov_b32 v76, 0
    v_mov_b32 v77, 0
    v_mov_b32 v78, 0
    v_mov_b32 v79, 0
    s_mov_b32 s32, s10
    s_mov_b32 s33, s11
    s_mov_b32 s34, 921600
    s_mov_b32 s35, 0x00020000
    s_lshr_b32 s42, s2, 3
    s_mul_i32 s48, s42, 28800
    s_mul_i32 s49, s4, 1800
    s_add_u32 s48, s48, s49
    s_and_b32 s48, s48, 0xffffff80
    v_bfe_u32 v249, v0, 4, 1
    v_mul_u32_u24 v249, 14400, v249
    v_and_b32 v10, 15, v0
    v_lshl_add_u32 v249, v10, 7, v249
    s_cmp_eq_u32 s40, 0
    s_cbranch_scc1 tw_30
    s_mov_b32 s32, s12
    s_mov_b32 s33, s13
    s_mov_b32 s34, 921600
    s_mov_b32 s35, 0x00020000
    s_cmp_eq_u32 s40, 1
    s_cbranch_scc1 tw_30
    s_mov_b32 s32, s18
    s_mov_b32 s33, s19
    s_mov_b32 s34, 401408
    s_mov_b32 s35, 0x00020000
    s_lshl_b32 s48, s42, 1
    s_add_u32 s48, s48, s40
    s_sub_u32 s48, s48, 2
    s_mul_i32 s48, s48, 6272
    s_and_b32 s49, s2, 1
    s_lshl_b32 s49, s49, 9
    s_add_u32 s48, s48, s49
    v_bfe_u32 v249, v0, 2, 3
    v_mul_u32_u24 v249, 896, v249
    v_and_b32 v10, 3, v0
    v_lshl_add_u32 v249, v10, 7, v249
tw_30:
lw_33:
    ds_read_b32 v13, v253 offset:220
    s_waitcnt lgkmcnt(0)
    v_readfirstlane_b32 s60, v13
    s_nop 0
    s_cmp_ge_u32 s60, 4
    s_cbranch_scc1 lwd_34
    s_sleep 2
    s_branch lw_33
lwd_34:
    s_mov_b32 exec_hi, 0
    buffer_load_dword v89, v249, s[32:35], s48 offen
    s_mov_b64 exec, -1
    s_mov_b32 s32, s18
    s_mov_b32 s33, s19
    s_mov_b32 s34, 401408
    s_mov_b32 s35, 0x00020000
    s_and_b32 s97, s2, 1
    s_lshl_b32 s97, s97, 1
    s_bfe_u32 s98, s2, 0x10003
    s_or_b32 s97, s97, s98
    s_lshl_b32 s97, s97, 8
    s_mul_i32 s98, s40, 3584
    s_add_u32 s97, s97, s98
    s_add_u32 s97, s97, 387072
    s_lshl_b32 s98, s40, 10
    s_add_u32 s98, s98, 110592
    s_mov_b32 s96, 28
    s_waitcnt vmcnt(0) lgkmcnt(0)
    s_cmp_ge_u32 s5, 29
    s_cbranch_scc1 L_noa2
    s_add_u32 m0, s43, 24576
    s_nop 0
    buffer_load_dwordx4 v248, s[28:31], s55 offen lds
    s_waitcnt vmcnt(0)
    s_add_u32 m0, s43, 25600
    s_nop 0
    buffer_load_dwordx4 v248, s[56:59], s55 offen lds
    s_cmp_lg_u32 s40, 0
    s_cbranch_scc1 pollw_37
    s_mov_b32 s61, 200000
poll_35:
    buffer_load_dword v10, v9, s[36:39], s46 offen sc1
    s_waitcnt vmcnt(0)
    v_cmp_ne_u32 vcc, s62, v10
    s_nop 0
    s_cbranch_vccz pollok_36
    s_sub_u32 s61, s61, 1
    s_cmp_eq_u32 s61, 0
    s_cbranch_scc1 pollok_36
    s_sleep 8
    s_branch poll_35
pollok_36:
    s_mov_b64 exec, 1
    ds_add_u32 v253, v254 offset:76
    s_mov_b64 exec, -1
    s_branch polle_38
pollw_37:
lw_39:
    ds_read_b32 v13, v253 offset:76
    s_waitcnt lgkmcnt(0)
    v_readfirstlane_b32 s60, v13
    s_nop 0
    s_cmp_ge_u32 s60, 1
    s_cbranch_scc1 lwd_40
    s_sleep 2
    s_branch lw_39
lwd_40:
polle_38:
    s_waitcnt vmcnt(0)
    s_add_u32 m0, s43, 16384
    s_setprio 2
    buffer_load_dwordx4 v1, s[36:39], s41 offen sc1 lds
    buffer_load_dwordx4 v1, s[36:39], s47 offen offset:1024 sc1 lds
    s_nop 0
    ds_read_u16_d16_hi v64, v2 offset:0
    ds_read_u16_d16_hi v65, v2 offset:64
    ds_read_u16_d16_hi v66, v2 offset:256
    ds_read_u16_d16_hi v67, v2 offset:320
    ds_read_u16_d16_hi v68, v2 offset:512
    ds_read_u16_d16_hi v69, v2 offset:576
    ds_read_u16_d16_hi v70, v2 offset:768
    ds_read_u16_d16_hi v71, v2 offset:832
    s_waitcnt lgkmcnt(4)
    ds_read_u16_d16_hi v72, v2 offset:1024
    ds_read_u16_d16_hi v73, v2 offset:1088
    ds_read_u16_d16_hi v74, v2 offset:1280
    ds_read_u16_d16_hi v75, v2 offset:1344
    ds_read_u16_d16_hi v76, v2 offset:1536
    ds_read_u16_d16_hi v77, v2 offset:1600
    ds_read_u16_d16_hi v78, v2 offset:1792
    ds_read_u16_d16_hi v79, v2 offset:1856
    s_waitcnt lgkmcnt(0)
    s_cmp_lg_u32 s5, 28
    s_cbranch_scc1 nyq_27
    v_xor_b32 v64, 0x80000000, v64
    v_xor_b32 v65, 0x80000000, v65
    v_xor_b32 v66, 0x80000000, v66
    v_xor_b32 v67, 0x80000000, v67
    v_xor_b32 v68, 0x80000000, v68
    v_xor_b32 v69, 0x80000000, v69
    v_xor_b32 v70, 0x80000000, v70
    v_xor_b32 v71, 0x80000000, v71
nyq_27:
    s_waitcnt vmcnt(0)
    s_mov_b64 exec, 1
    ds_add_rtn_u32 v13, v253, v254 offset:268
    s_mov_b64 exec, -1
    s_waitcnt lgkmcnt(0)
    v_readfirstlane_b32 s60, v13
    s_nop 0
    s_cmp_eq_u32 s60, 3
    s_cbranch_scc1 sy_41
lw_42:
    ds_read_b32 v13, v253 offset:268
    s_waitcnt lgkmcnt(0)
    v_readfirstlane_b32 s60, v13
    s_nop 0
    s_cmp_ge_u32 s60, 4
    s_cbranch_scc1 lwd_43
    s_sleep 2
    s_branch lw_42
lwd_43:
sy_41:
wo_44:
    s_cmp_le_i32 s96, 24
    s_cbranch_scc1 wod_45
    s_mov_b32 m0, s98
    s_waitcnt vmcnt(3)
    buffer_load_dwordx4 v250, s[32:35], s97 offen lds
    s_sub_u32 s98, s98, 4096
    s_sub_u32 s97, s97, 14336
    s_sub_u32 s96, s96, 1
    s_branch wo_44
wod_45:
    ds_read2st64_b32 v[16:17], v5 offset0:0 offset1:1
    ds_read2st64_b32 v[18:19], v5 offset0:2 offset1:3
    ds_read2st64_b32 v[20:21], v5 offset0:4 offset1:5
    ds_read2st64_b32 v[22:23], v5 offset0:6 offset1:7
    ds_read2st64_b32 v[24:25], v5 offset0:8 offset1:9
    ds_read2st64_b32 v[26:27], v5 offset0:10 offset1:11
    ds_read2st64_b32 v[28:29], v5 offset0:12 offset1:13
    ds_read2st64_b32 v[30:31], v5 offset0:14 offset1:15
    ds_read2st64_b32 v[32:33], v5 offset0:16 offset1:17
    ds_read2st64_b32 v[34:35], v5 offset0:18 offset1:19
    ds_read2st64_b32 v[36:37], v5 offset0:20 offset1:21
    ds_read2st64_b32 v[38:39], v5 offset0:22 offset1:23
    ds_read2st64_b32 v[40:41], v5 offset0:24 offset1:25
    ds_read2st64_b32 v[42:43], v5 offset0:26 offset1:27
    s_waitcnt lgkmcnt(12)
    v_mfma_f32_32x32x16_bf16 v[48:63], v[128:131], v[16:19], 0
    ds_read2st64_b32 v[44:45], v5 offset0:28 offset1:29
    ds_read2st64_b32 v[46:47], v5 offset0:30 offset1:31
    s_waitcnt lgkmcnt(12)
    v_mfma_f32_32x32x16_bf16 v[48:63], v[132:135], v[20:23], v[48:63]
    s_waitcnt lgkmcnt(10)
    v_mfma_f32_32x32x16_bf16 v[48:63], v[136:139], v[24:27], v[48:63]
    s_waitcnt lgkmcnt(8)
    v_mfma_f32_32x32x16_bf16 v[48:63], v[140:143], v[28:31], v[48:63]
    s_waitcnt lgkmcnt(6)
    v_mfma_f32_32x32x16_bf16 v[48:63], v[144:147], v[32:35], v[48:63]
    s_waitcnt lgkmcnt(4)
    v_mfma_f32_32x32x16_bf16 v[48:63], v[148:151], v[36:39], v[48:63]
    s_waitcnt lgkmcnt(2)
    v_mfma_f32_32x32x16_bf16 v[48:63], v[152:155], v[40:43], v[48:63]
    s_waitcnt lgkmcnt(0)
    v_mfma_f32_32x32x16_bf16 v[48:63], v[156:159], v[44:47], v[48:63]
    s_nop 11
    v_mul_f32 v10, v48, v64
    v_mul_f32 v11, v48, v72
    v_fma_f32 v10, -v49, v72, v10
    v_fmac_f32 v11, v49, v64
    v_cvt_pk_bf16_f32 v80, v11, v10
    v_mul_f32 v10, v50, v65
    v_mul_f32 v11, v50, v73
    v_fma_f32 v10, -v51, v73, v10
    v_fmac_f32 v11, v51, v65
    v_cvt_pk_bf16_f32 v81, v11, v10
    v_mul_f32 v10, v52, v66
    v_mul_f32 v11, v52, v74
    v_fma_f32 v10, -v53, v74, v10
    v_fmac_f32 v11, v53, v66
    v_cvt_pk_bf16_f32 v82, v11, v10
    v_mul_f32 v10, v54, v67
    v_mul_f32 v11, v54, v75
    v_fma_f32 v10, -v55, v75, v10
    v_fmac_f32 v11, v55, v67
    v_cvt_pk_bf16_f32 v83, v11, v10
    ds_write_b128 v7, v[80:83]
    v_mul_f32 v10, v56, v68
    v_mul_f32 v11, v56, v76
    v_fma_f32 v10, -v57, v76, v10
    v_fmac_f32 v11, v57, v68
    v_cvt_pk_bf16_f32 v84, v11, v10
    v_mul_f32 v10, v58, v69
    v_mul_f32 v11, v58, v77
    v_fma_f32 v10, -v59, v77, v10
    v_fmac_f32 v11, v59, v69
    v_cvt_pk_bf16_f32 v85, v11, v10
    v_mul_f32 v10, v60, v70
    v_mul_f32 v11, v60, v78
    v_fma_f32 v10, -v61, v78, v10
    v_fmac_f32 v11, v61, v70
    v_cvt_pk_bf16_f32 v86, v11, v10
    v_mul_f32 v10, v62, v71
    v_mul_f32 v11, v62, v79
    v_fma_f32 v10, -v63, v79, v10
    v_fmac_f32 v11, v63, v71
    v_cvt_pk_bf16_f32 v87, v11, v10
    ds_write_b128 v7, v[84:87] offset:1024
    s_mov_b64 exec, 1
    ds_add_rtn_u32 v13, v253, v254 offset:92
    s_mov_b64 exec, -1
    s_waitcnt lgkmcnt(0)
    v_readfirstlane_b32 s60, v13
    s_nop 0
    s_cmp_eq_u32 s60, 3
    s_cbranch_scc1 sy_46
lw_47:
    ds_read_b32 v13, v253 offset:92
    s_waitcnt lgkmcnt(0)
    v_readfirstlane_b32 s60, v13
    s_nop 0
    s_cmp_ge_u32 s60, 4
    s_cbranch_scc1 lwd_48
    s_sleep 2
    s_branch lw_47
lwd_48:
sy_46:
wo_49:
    s_cmp_le_i32 s96, 20
    s_cbranch_scc1 wod_50
    s_mov_b32 m0, s98
    s_waitcnt vmcnt(3)
    buffer_load_dwordx4 v250, s[32:35], s97 offen lds
    s_sub_u32 s98, s98, 4096
    s_sub_u32 s97, s97, 14336
    s_sub_u32 s96, s96, 1
    s_branch wo_49
wod_50:
    ds_read_b128 v[16:19], v8 offset:0
    ds_read_b128 v[20:23], v8 offset:1024
    ds_read_b128 v[24:27], v8 offset:2048
    ds_read_b128 v[28:31], v8 offset:3072
    ds_read_b128 v[32:35], v8 offset:4096
    ds_read_b128 v[36:39], v8 offset:5120
    ds_read_b128 v[40:43], v8 offset:6144
    ds_read_b128 v[44:47], v8 offset:7168
    s_waitcnt lgkmcnt(7)
    v_mfma_f32_32x32x16_bf16 v[48:63], v[128:131], v[16:19], 0
    s_waitcnt lgkmcnt(6)
    v_mfma_f32_32x32x16_bf16 v[48:63], v[132:135], v[20:23], v[48:63]
    s_waitcnt lgkmcnt(5)
    v_mfma_f32_32x32x16_bf16 v[48:63], v[136:139], v[24:27], v[48:63]
    s_waitcnt lgkmcnt(4)
    v_mfma_f32_32x32x16_bf16 v[48:63], v[140:143], v[28:31], v[48:63]
    s_waitcnt lgkmcnt(3)
    v_mfma_f32_32x32x16_bf16 v[48:63], v[144:147], v[32:35], v[48:63]
    s_waitcnt lgkmcnt(2)
    v_mfma_f32_32x32x16_bf16 v[48:63], v[148:151], v[36:39], v[48:63]
    s_waitcnt lgkmcnt(1)
    v_mfma_f32_32x32x16_bf16 v[48:63], v[152:155], v[40:43], v[48:63]
    s_waitcnt lgkmcnt(0)
    v_mfma_f32_32x32x16_bf16 v[48:63], v[156:159], v[44:47], v[48:63]
    s_nop 11
    v_cvt_pk_bf16_f32 v80, v49, v48
    v_cvt_pk_bf16_f32 v81, v51, v50
    ds_write2_b32 v3, v80, v81 offset0:0 offset1:32
    v_cvt_pk_bf16_f32 v82, v53, v52
    v_cvt_pk_bf16_f32 v83, v55, v54
    ds_write2_b32 v3, v82, v83 offset0:128 offset1:160
    v_cvt_pk_bf16_f32 v84, v57, v56
    v_cvt_pk_bf16_f32 v85, v59, v58
    ds_write2_b32 v6, v84, v85 offset0:0 offset1:32
    v_cvt_pk_bf16_f32 v86, v61, v60
    v_cvt_pk_bf16_f32 v87, v63, v62
    ds_write2_b32 v6, v86, v87 offset0:128 offset1:160
    ds_read_b128 v[16:19], v7 offset:16384
    ds_read_b128 v[20:23], v7 offset:17408
    s_add_u32 s43, s53, 237568
    s_waitcnt lgkmcnt(1)
    buffer_store_dwordx4 v[16:19], v88, s[36:39], s53 offen sc1
    s_waitcnt lgkmcnt(0)
    buffer_store_dwordx4 v[20:23], v88, s[36:39], s43 offen sc1
    s_setprio 2
    s_mov_b64 exec, 1
    s_waitcnt vmcnt(0)
    ds_add_rtn_u32 v13, v253, v254 offset:108
    s_mov_b64 exec, -1
    s_waitcnt lgkmcnt(0)
    v_readfirstlane_b32 s60, v13
    s_nop 0
    s_cmp_lg_u32 s60, 3
    s_cbranch_scc1 pub2_28
    s_lshl_b32 s41, s2, 7
    s_add_u32 s41, s41, 327680
    v_lshrrev_b32 v12, 3, v0
    v_mul_u32_u24 v12, 32768, v12
    v_and_b32 v13, 7, v0
    v_lshl_add_u32 v12, v13, 4, v12
    v_mov_b32 v40, s62
    v_mov_b32 v41, s62
    v_mov_b32 v42, s62
    v_mov_b32 v43, s62
    buffer_store_dwordx4 v[40:43], v12, s[36:39], s41 offen sc1
pub2_28:
lw_51:
    ds_read_b32 v13, v253 offset:108
    s_waitcnt lgkmcnt(0)
    v_readfirstlane_b32 s60, v13
    s_nop 0
    s_cmp_ge_u32 s60, 4
    s_cbranch_scc1 lwd_52
    s_sleep 4
    s_branch lw_51
lwd_52:
L_noa2:
wo_53:
    s_cmp_le_i32 s96, 0
    s_cbranch_scc1 wod_54
    s_mov_b32 m0, s98
    s_waitcnt vmcnt(3)
    buffer_load_dwordx4 v250, s[32:35], s97 offen lds
    s_sub_u32 s98, s98, 4096
    s_sub_u32 s97, s97, 14336
    s_sub_u32 s96, s96, 1
    s_branch wo_53
wod_54:
    s_waitcnt vmcnt(0)
    s_mov_b64 exec, 1
    ds_add_u32 v253, v254 offset:172
    s_mov_b64 exec, -1
    s_mul_i32 s41, s50, 29696
    s_add_u32 s41, s41, 8585216
    s_lshl_b32 s42, s40, 9
    s_add_u32 s42, s42, s41
    s_and_b32 s46, s2, 7
    s_lshl_b32 s46, s46, 15
    s_add_u32 s46, s46, 327680
    s_add_u32 s47, s46, 28672
    s_mov_b32 s32, s20
    s_mov_b32 s33, s21
    s_mov_b32 s34, 3670016
    s_mov_b32 s35, 0x00020000
    s_mov_b32 s61, 200000
spin_55:
    buffer_load_dword v10, v255, s[36:39], s46 offen sc1
    s_waitcnt vmcnt(0)
    v_cmp_ne_u32 vcc, s62, v10
    s_nop 0
    s_cbranch_vccz spinok_56
    s_sub_u32 s61, s61, 1
    s_cmp_eq_u32 s61, 0
    s_cbranch_scc1 spinok_56
    s_sleep 16
    s_branch spin_55
spinok_56:
    s_add_u32 s43, s42, 0
    buffer_load_dwordx4 v[16:19], v251, s[36:39], s43 offen sc1
    s_add_u32 s43, s42, 7424
    buffer_load_dwordx4 v[20:23], v251, s[36:39], s43 offen sc1
    s_add_u32 s43, s42, 14848
    buffer_load_dwordx4 v[24:27], v251, s[36:39], s43 offen sc1
    s_add_u32 s43, s42, 22272
    buffer_load_dwordx4 v[28:31], v251, s[36:39], s43 offen sc1
    s_cmp_eq_u32 s40, 3
    s_cbranch_scc1 a3l_57
    s_add_u32 s43, s42, 2048
    buffer_load_dwordx4 v[32:35], v251, s[36:39], s43 offen sc1
    s_add_u32 s43, s42, 9472
    buffer_load_dwordx4 v[36:39], v251, s[36:39], s43 offen sc1
    s_add_u32 s43, s42, 16896
    buffer_load_dwordx4 v[40:43], v251, s[36:39], s43 offen sc1
    s_add_u32 s43, s42, 24320
    buffer_load_dwordx4 v[44:47], v251, s[36:39], s43 offen sc1
a3l_57:
    s_cmp_lg_u32 s40, 0
    s_cbranch_scc1 a3l_58
    s_mov_b32 s61, 200000
spin_59:
    s_mov_b64 exec, 0xff
    buffer_load_dword v10, v255, s[36:39], s47 offen sc1
    s_waitcnt vmcnt(0)
    v_cmp_ne_u32 vcc, s62, v10
    s_nop 0
    s_cbranch_vccz spinok_60
    s_sub_u32 s61, s61, 1
    s_cmp_eq_u32 s61, 0
    s_cbranch_scc1 spinok_60
    s_sleep 16
    s_branch spin_59
spinok_60:
    s_mov_b64 exec, -1
    s_add_u32 s43, s41, 0
    buffer_load_dwordx4 v[48:51], v252, s[36:39], s43 offen sc1
    s_add_u32 s43, s41, 7424
    buffer_load_dwordx4 v[52:55], v252, s[36:39], s43 offen sc1
    s_add_u32 s43, s41, 14848
    buffer_load_dwordx4 v[56:59], v252, s[36:39], s43 offen sc1
    s_add_u32 s43, s41, 22272
    buffer_load_dwordx4 v[60:63], v252, s[36:39], s43 offen sc1
a3l_58:
lw_61:
    ds_read_b32 v13, v253 offset:204
    s_waitcnt lgkmcnt(0)
    v_readfirstlane_b32 s60, v13
    s_nop 0
    s_cmp_ge_u32 s60, 4
    s_cbranch_scc1 lwd_62
    s_sleep 8
    s_branch lw_61
lwd_62:
    s_setprio 0
    s_waitcnt vmcnt(0)
    v_mfma_f32_32x32x16_bf16 v[64:79], v[16:19], v[160:163], 0
    v_lshlrev_b32 v5, 4, v0
    s_lshl_b32 s43, s40, 11
    s_add_u32 s43, s43, 114688
    v_add_u32 v6, s43, v5
    s_mul_i32 s43, s52, 14336
    v_mfma_f32_32x32x16_bf16 v[64:79], v[20:23], v[164:167], v[64:79]
    s_add_u32 s43, s43, 114688
    v_add_u32 v5, s43, v5
    s_lshr_b32 s46, s40, 1
    s_lshl_b32 s46, s46, 3
    v_add_u32 v7, s46, v15
    v_mfma_f32_32x32x16_bf16 v[64:79], v[24:27], v[168:171], v[64:79]
    v_and_b32 v9, 7, v14
    v_xor_b32 v7, v7, v9
    v_lshlrev_b32 v7, 4, v7
    v_lshl_or_b32 v7, v14, 8, v7
    s_lshl_b32 s46, s52, 13
    v_mfma_f32_32x32x16_bf16 v[64:79], v[28:31], v[172:175], v[64:79]
    s_add_u32 s46, s46, 143360
    v_add_u32 v7, s46, v7
    v_lshrrev_b32 v8, 3, v0
    s_lshl_b32 s46, s40, 3
    v_add_u32 v8, s46, v8
    v_mfma_f32_32x32x16_bf16 v[96:111], v[32:35], v[160:163], 0
    v_and_b32 v9, 7, v0
    v_lshlrev_b32 v10, 1, v9
    v_and_b32 v11, 7, v8
    v_xor_b32 v10, v10, v11
    v_lshlrev_b32 v10, 4, v10
    v_mfma_f32_32x32x16_bf16 v[96:111], v[36:39], v[164:167], v[96:111]
    v_lshl_or_b32 v10, v8, 8, v10
    v_add_u32 v10, 143360, v10
    v_xor_b32 v11, 16, v10
    v_mul_u32_u24 v8, 114688, v8
    v_lshl_add_u32 v8, v9, 4, v8
    v_mfma_f32_32x32x16_bf16 v[96:111], v[40:43], v[168:171], v[96:111]
    s_mul_i32 s41, s50, 1792
    s_lshl_b32 s42, s51, 7
    s_add_u32 s41, s41, s42
    v_mfma_f32_32x32x16_bf16 v[96:111], v[44:47], v[172:175], v[96:111]
    s_cmp_eq_u32 s51, 3
    s_cselect_b32 s42, 4, 8
    v_cmp_gt_u32 s[48:49], s42, v9
    s_cmp_lg_u32 s40, 0
    s_cbranch_scc1 a3ny_63
    s_mov_b32 exec_lo, 1
    s_mov_b32 exec_hi, 1
    v_mov_b32 v16, v48
    v_mov_b32 v17, v49
    v_mov_b32 v18, v50
    v_mov_b32 v19, v51
    v_mov_b32 v20, v52
    v_mov_b32 v21, v53
    v_mov_b32 v22, v54
    v_mov_b32 v23, v55
    v_mov_b32 v24, v56
    v_mov_b32 v25, v57
    v_mov_b32 v26, v58
    v_mov_b32 v27, v59
    v_mov_b32 v28, v60
    v_mov_b32 v29, v61
    v_mov_b32 v30, v62
    v_mov_b32 v31, v63
    s_mov_b64 exec, -1
a3ny_63:
    s_nop 1
    v_mfma_f32_32x32x16_bf16 v[80:95], v[16:19], v[176:179], 0
    v_cvt_pk_bf16_f32 v48, v64, v66
    v_cvt_pk_bf16_f32 v49, v68, v70
    v_cvt_pk_bf16_f32 v50, v72, v74
    v_mfma_f32_32x32x16_bf16 v[80:95], v[20:23], v[180:183], v[80:95]
    v_cvt_pk_bf16_f32 v51, v76, v78
    v_cvt_pk_bf16_f32 v52, v65, v67
    v_cvt_pk_bf16_f32 v53, v69, v71
    v_mfma_f32_32x32x16_bf16 v[80:95], v[24:27], v[184:187], v[80:95]
    v_cvt_pk_bf16_f32 v54, v73, v75
    v_cvt_pk_bf16_f32 v55, v77, v79
    ds_write_b128 v6, v[48:51] offset:0
    v_mfma_f32_32x32x16_bf16 v[80:95], v[28:31], v[188:191], v[80:95]
    ds_write_b128 v6, v[52:55] offset:14336
    v_mfma_f32_32x32x16_bf16 v[112:127], v[32:35], v[176:179], 0
    v_mfma_f32_32x32x16_bf16 v[112:127], v[36:39], v[180:183], v[112:127]
    v_mfma_f32_32x32x16_bf16 v[112:127], v[40:43], v[184:187], v[112:127]
    v_mfma_f32_32x32x16_bf16 v[112:127], v[44:47], v[188:191], v[112:127]
    s_nop 6
    v_cvt_pk_bf16_f32 v16, v80, v82
    v_cvt_pk_bf16_f32 v17, v84, v86
    v_cvt_pk_bf16_f32 v18, v88, v90
    v_cvt_pk_bf16_f32 v19, v92, v94
    v_cvt_pk_bf16_f32 v20, v81, v83
    v_cvt_pk_bf16_f32 v21, v85, v87
    v_cvt_pk_bf16_f32 v22, v89, v91
    v_cvt_pk_bf16_f32 v23, v93, v95
    ds_write_b128 v6, v[16:19] offset:1024
    ds_write_b128 v6, v[20:23] offset:15360
    s_cmp_eq_u32 s40, 3
    s_cbranch_scc1 a3z_64
    v_cvt_pk_bf16_f32 v56, v96, v98
    v_cvt_pk_bf16_f32 v57, v100, v102
    v_cvt_pk_bf16_f32 v58, v104, v106
    v_cvt_pk_bf16_f32 v59, v108, v110
    v_cvt_pk_bf16_f32 v60, v97, v99
    v_cvt_pk_bf16_f32 v61, v101, v103
    v_cvt_pk_bf16_f32 v62, v105, v107
    v_cvt_pk_bf16_f32 v63, v109, v111
    ds_write_b128 v6, v[56:59] offset:8192
    ds_write_b128 v6, v[60:63] offset:22528
    v_cvt_pk_bf16_f32 v24, v112, v114
    v_cvt_pk_bf16_f32 v25, v116, v118
    v_cvt_pk_bf16_f32 v26, v120, v122
    v_cvt_pk_bf16_f32 v27, v124, v126
    v_cvt_pk_bf16_f32 v28, v113, v115
    v_cvt_pk_bf16_f32 v29, v117, v119
    v_cvt_pk_bf16_f32 v30, v121, v123
    v_cvt_pk_bf16_f32 v31, v125, v127
    ds_write_b128 v6, v[24:27] offset:9216
    ds_write_b128 v6, v[28:31] offset:23552
a3z_64:
    s_mov_b64 exec, 1
    ds_add_rtn_u32 v13, v253, v254 offset:140
    s_mov_b64 exec, -1
    s_waitcnt lgkmcnt(0)
    v_readfirstlane_b32 s60, v13
    s_nop 0
    s_cmp_eq_u32 s60, 3
    s_cbranch_scc1 sy_65
lw_66:
    ds_read_b32 v13, v253 offset:140
    s_waitcnt lgkmcnt(0)
    v_readfirstlane_b32 s60, v13
    s_nop 0
    s_cmp_ge_u32 s60, 4
    s_cbranch_scc0 lw_66
sy_65:
    s_add_u32 s42, s2, s3
    s_cmp_lg_u32 s42, 0
    s_cbranch_scc1 ep_68
    v_lshrrev_b32 v12, 3, v0
    v_mul_u32_u24 v12, 0, v12
    v_and_b32 v13, 7, v0
    v_lshl_add_u32 v12, v13, 4, v12
    v_mov_b32 v72, s62
    v_mov_b32 v73, s62
    v_mov_b32 v74, s62
    v_mov_b32 v75, s62
    s_bfm_b64 exec, 8, 0
    buffer_store_dwordx4 v[72:75], v12, s[36:39], 0 offen sc1
    s_mov_b64 exec, -1
ep_68:
    ds_read_b128 v[16:19], v5 offset:0
    ds_read_b128 v[20:23], v5 offset:1024
    ds_read_b128 v[24:27], v5 offset:2048
    ds_read_b128 v[28:31], v5 offset:3072
    ds_read_b128 v[32:35], v5 offset:4096
    ds_read_b128 v[36:39], v5 offset:5120
    ds_read_b128 v[40:43], v5 offset:6144
    ds_read_b128 v[44:47], v5 offset:7168
    ds_read_b128 v[48:51], v5 offset:8192
    ds_read_b128 v[52:55], v5 offset:9216
    ds_read_b128 v[56:59], v5 offset:10240
    ds_read_b128 v[60:63], v5 offset:11264
    ds_read_b128 v[64:67], v5 offset:12288
    ds_read_b128 v[68:71], v5 offset:13312
    s_waitcnt lgkmcnt(13)
    v_mfma_f32_32x32x16_bf16 v[112:127], v[192:195], v[16:19], 0
    s_waitcnt lgkmcnt(12)
    v_mfma_f32_32x32x16_bf16 v[112:127], v[196:199], v[20:23], v[112:127]
    s_waitcnt lgkmcnt(11)
    v_mfma_f32_32x32x16_bf16 v[112:127], v[200:203], v[24:27], v[112:127]
    s_waitcnt lgkmcnt(10)
    v_mfma_f32_32x32x16_bf16 v[112:127], v[204:207], v[28:31], v[112:127]
    s_waitcnt lgkmcnt(9)
    v_mfma_f32_32x32x16_bf16 v[112:127], v[208:211], v[32:35], v[112:127]
    s_waitcnt lgkmcnt(8)
    v_mfma_f32_32x32x16_bf16 v[112:127], v[212:215], v[36:39], v[112:127]
    s_waitcnt lgkmcnt(7)
    v_mfma_f32_32x32x16_bf16 v[112:127], v[216:219], v[40:43], v[112:127]
    s_waitcnt lgkmcnt(6)
    v_mfma_f32_32x32x16_bf16 v[112:127], v[220:223], v[44:47], v[112:127]
    s_waitcnt lgkmcnt(5)
    v_mfma_f32_32x32x16_bf16 v[112:127], v[224:227], v[48:51], v[112:127]
    s_waitcnt lgkmcnt(4)
    v_mfma_f32_32x32x16_bf16 v[112:127], v[228:231], v[52:55], v[112:127]
    s_waitcnt lgkmcnt(3)
    v_mfma_f32_32x32x16_bf16 v[112:127], v[232:235], v[56:59], v[112:127]
    s_waitcnt lgkmcnt(2)
    v_mfma_f32_32x32x16_bf16 v[112:127], v[236:239], v[60:63], v[112:127]
    s_waitcnt lgkmcnt(1)
    v_mfma_f32_32x32x16_bf16 v[112:127], v[240:243], v[64:67], v[112:127]
    s_waitcnt lgkmcnt(0)
    v_mfma_f32_32x32x16_bf16 v[112:127], v[244:247], v[68:71], v[112:127]
    v_xor_b32 v9, 0, v7
    s_nop 10
    ds_write_b128 v9, v[112:115]
    v_xor_b32 v9, 32, v7
    ds_write_b128 v9, v[116:119]
    v_xor_b32 v9, 64, v7
    ds_write_b128 v9, v[120:123]
    v_xor_b32 v9, 96, v7
    ds_write_b128 v9, v[124:127]
    s_mov_b64 exec, 1
    ds_add_rtn_u32 v13, v253, v254 offset:156
    s_mov_b64 exec, -1
    s_waitcnt lgkmcnt(0)
    v_readfirstlane_b32 s60, v13
    s_nop 0
    s_cmp_eq_u32 s60, 3
    s_cbranch_scc1 sy_69
lw_70:
    ds_read_b32 v13, v253 offset:156
    s_waitcnt lgkmcnt(0)
    v_readfirstlane_b32 s60, v13
    s_nop 0
    s_cmp_ge_u32 s60, 4
    s_cbranch_scc0 lw_70
sy_69:
    ds_read_b128 v[16:19], v10
    ds_read_b128 v[20:23], v11
    ds_read_b128 v[24:27], v10 offset:8192
    ds_read_b128 v[28:31], v11 offset:8192
    s_waitcnt lgkmcnt(0)
    v_add_f32 v32, v16, v24
    v_sub_f32 v40, v16, v24
    v_add_f32 v33, v17, v25
    v_sub_f32 v41, v17, v25
    v_add_f32 v34, v18, v26
    v_sub_f32 v42, v18, v26
    v_add_f32 v35, v19, v27
    v_sub_f32 v43, v19, v27
    v_add_f32 v36, v20, v28
    v_sub_f32 v44, v20, v28
    v_add_f32 v37, v21, v29
    v_sub_f32 v45, v21, v29
    v_add_f32 v38, v22, v30
    v_sub_f32 v46, v22, v30
    v_add_f32 v39, v23, v31
    v_sub_f32 v47, v23, v31
    v_cvt_pk_bf16_f32 v48, v32, v33
    v_cvt_pk_bf16_f32 v49, v34, v35
    v_cvt_pk_bf16_f32 v50, v36, v37
    v_cvt_pk_bf16_f32 v51, v38, v39
    v_cvt_pk_bf16_f32 v52, v40, v41
    v_cvt_pk_bf16_f32 v53, v42, v43
    v_cvt_pk_bf16_f32 v54, v44, v45
    v_cvt_pk_bf16_f32 v55, v46, v47
lw_72:
    ds_read_b32 v13, v253 offset:60
    s_waitcnt lgkmcnt(0)
    v_readfirstlane_b32 s60, v13
    s_nop 0
    s_cmp_ge_u32 s60, 4
    s_cbranch_scc1 lwd_73
    s_sleep 1
    s_branch lw_72
lwd_73:
    s_mov_b64 exec, s[48:49]
    buffer_store_dwordx4 v[48:51], v8, s[32:35], s41 offen sc1
    buffer_store_dwordx4 v[52:55], v8, s[32:35], s41 offen offset:448 sc1
    s_mov_b64 exec, -1
    s_branch L_end
L_att:
    s_setprio 0
    s_mov_b32 s51, s7
    s_mov_b32 s32, s20
    s_mov_b32 s33, s21
    s_mov_b32 s34, 3670016
    s_mov_b32 s35, 0x00020000
    s_lshl_b32 s4, s4, 1
    s_bfe_u32 s5, s2, 0x10003
    s_or_b32 s4, s4, s5
    s_lshr_b32 s5, s2, 4
    s_mul_i32 s6, s4, 7
    s_lshr_b32 s45, s6, 1
    s_add_u32 s6, s6, 1
    s_lshr_b32 s6, s6, 1
    s_lshl_b32 s6, s6, 9
    v_lshlrev_b32 v8, 4, v0
    v_add_u32 v1, s6, v8
    s_bitcmp1_b32 s4, 0
    s_cselect_b32 s7, -2040, 0
    v_add_u32 v2, 1024, v1
    v_add_u32 v6, s7, v2
    v_mov_b32 v4, 0x3f80
    s_nop 0
    v_mov_b32_dpp v2, v6 quad_perm:[0,1,2,3] row_mask:0xc bank_mask:0xf
    s_lshl_b32 s7, s4, 11
    s_add_u32 s7, s7, 28672
    v_and_b32 v9, 30, v0
    v_cmp_eq_u32 vcc, 26, v9
    v_cmp_eq_u32 s[48:49], 28, v9
    s_nop 0
    s_or_b64 vcc, vcc, s[48:49]
    v_xor_b32 v9, 96, v8
    v_cndmask_b32 v3, v8, v9, vcc
    v_add_u32 v3, s7, v3
    v_mov_b32 v5, 0xdddd
    v_mov_b32 v7, 0
    s_lshl_b32 s45, s45, 3
    v_bfe_u32 v9, v0, 2, 1
    v_mul_u32_u24 v10, 31, v9
    v_add_u32 v10, s45, v10
    v_add_u32 v11, 448, v10
    v_mul_u32_u24 v9, 27, v9
    s_mul_i32 s46, s4, 28
    s_add_u32 s46, s46, 896
    v_add_u32 v9, s46, v9
    v_lshrrev_b32 v10, 7, v10
    v_lshlrev_b32 v10, 11, v10
    v_mov_b32_dpp v11, v9 quad_perm:[0,1,2,3] row_mask:0xa bank_mask:0xf
    s_lshl_b32 s46, s5, 7
    v_add_u32 v10, s46, v10
    v_lshrrev_b32 v11, 7, v11
    v_lshlrev_b32 v11, 11, v11
    v_and_b32 v9, 3, v0
    v_lshl_add_u32 v11, v9, 7, v11
    s_lshl_b32 s46, s40, 9
    v_add_u32 v11, s46, v11
    s_nop 1
    v_mov_b32_dpp v11, v10 quad_perm:[0,1,2,3] row_mask:0xc bank_mask:0xf
    s_and_b32 s46, s2, 7
    s_lshl_b32 s46, s46, 15
    s_add_u32 s46, s46, 65536
    s_lshl_b32 s43, s5, 2
    s_add_u32 s42, s40, s43
    s_mul_i32 s42, s42, 28672
    s_add_u32 s50, s42, 851968
    s_mul_i32 s47, s40, 983040
    s_add_u32 s47, s47, 2686976
    s_and_b32 s43, s5, 0
    s_add_u32 s42, s43, 0
    s_and_b32 s42, s42, 15
    s_mul_i32 s42, s42, 61440
    s_add_u32 s8, s42, s47
    s_add_u32 s42, s43, 1
    s_and_b32 s42, s42, 15
    s_mul_i32 s42, s42, 61440
    s_add_u32 s9, s42, s47
    s_add_u32 s42, s43, 2
    s_and_b32 s42, s42, 15
    s_mul_i32 s42, s42, 61440
    s_add_u32 s10, s42, s47
    s_add_u32 s42, s43, 3
    s_and_b32 s42, s42, 15
    s_mul_i32 s42, s42, 61440
    s_add_u32 s11, s42, s47
    s_add_u32 s42, s43, 4
    s_and_b32 s42, s42, 15
    s_mul_i32 s42, s42, 61440
    s_add_u32 s12, s42, s47
    s_add_u32 s42, s43, 5
    s_and_b32 s42, s42, 15
    s_mul_i32 s42, s42, 61440
    s_add_u32 s13, s42, s47
    s_add_u32 s42, s43, 6
    s_and_b32 s42, s42, 15
    s_mul_i32 s42, s42, 61440
    s_add_u32 s14, s42, s47
    s_add_u32 s42, s43, 7
    s_and_b32 s42, s42, 15
    s_mul_i32 s42, s42, 61440
    s_add_u32 s15, s42, s47
    s_add_u32 s42, s43, 8
    s_and_b32 s42, s42, 15
    s_mul_i32 s42, s42, 61440
    s_add_u32 s16, s42, s47
    s_add_u32 s42, s43, 9
    s_and_b32 s42, s42, 15
    s_mul_i32 s42, s42, 61440
    s_add_u32 s17, s42, s47
    s_add_u32 s42, s43, 10
    s_and_b32 s42, s42, 15
    s_mul_i32 s42, s42, 61440
    s_add_u32 s18, s42, s47
    s_add_u32 s42, s43, 11
    s_and_b32 s42, s42, 15
    s_mul_i32 s42, s42, 61440
    s_add_u32 s19, s42, s47
    s_add_u32 s42, s43, 12
    s_and_b32 s42, s42, 15
    s_mul_i32 s42, s42, 61440
    s_add_u32 s20, s42, s47
    s_add_u32 s42, s43, 13
    s_and_b32 s42, s42, 15
    s_mul_i32 s42, s42, 61440
    s_add_u32 s21, s42, s47
    s_add_u32 s42, s43, 14
    s_and_b32 s42, s42, 15
    s_mul_i32 s42, s42, 61440
    s_add_u32 s22, s42, s47
    s_add_u32 s42, s43, 15
    s_and_b32 s42, s42, 15
    s_mul_i32 s42, s42, 61440
    s_add_u32 s23, s42, s47
    s_add_u32 s42, s40, 0
    s_and_b32 s42, s42, 3
    s_lshl_b32 s42, s42, 11
    s_add_u32 s42, s42, 0
    v_add_u32 v240, s42, v8
    s_add_u32 s42, s40, 1
    s_and_b32 s42, s42, 3
    s_mul_i32 s42, s42, 12288
    s_add_u32 s42, s42, 114688
    v_add_u32 v244, s42, v8
    s_add_u32 s42, s40, 1
    s_and_b32 s42, s42, 3
    s_lshl_b32 s42, s42, 11
    s_add_u32 s42, s42, 0
    v_add_u32 v241, s42, v8
    s_add_u32 s42, s40, 2
    s_and_b32 s42, s42, 3
    s_mul_i32 s42, s42, 12288
    s_add_u32 s42, s42, 118784
    v_add_u32 v245, s42, v8
    s_add_u32 s42, s40, 2
    s_and_b32 s42, s42, 3
    s_lshl_b32 s42, s42, 11
    s_add_u32 s42, s42, 0
    v_add_u32 v242, s42, v8
    s_add_u32 s42, s40, 3
    s_and_b32 s42, s42, 3
    s_mul_i32 s42, s42, 12288
    s_add_u32 s42, s42, 122880
    v_add_u32 v246, s42, v8
    s_add_u32 s42, s40, 3
    s_and_b32 s42, s42, 3
    s_lshl_b32 s42, s42, 11
    s_add_u32 s42, s42, 0
    v_add_u32 v243, s42, v8
    s_add_u32 s42, s40, 4
    s_and_b32 s42, s42, 3
    s_mul_i32 s42, s42, 12288
    s_add_u32 s42, s42, 114688
    v_add_u32 v247, s42, v8
    s_add_u32 s41, s40, 3
    s_and_b32 s41, s41, 3
    s_lshl_b32 s43, s5, 2
    s_add_u32 s41, s41, s43
    s_lshl_b32 s26, s41, 15
    s_lshl_b32 s42, s4, 11
    s_add_u32 s26, s26, s42
    s_add_u32 s26, s26, 10551296
    s_lshl_b32 s27, s41, 11
    s_lshl_b32 s42, s4, 7
    s_add_u32 s27, s27, s42
    s_add_u32 s27, s27, 589824
    s_bfe_u32 s42, s2, 0x20001
    s_or_b32 s43, s43, s42
    s_and_b32 s53, s2, 1
    s_and_b32 s52, s53, 1
    s_lshl_b32 s53, s53, 1
    s_bfe_u32 s42, s2, 0x10003
    s_or_b32 s53, s53, s42
    s_lshl_b32 s52, s52, 17
    s_lshl_b32 s53, s53, 2
    s_add_u32 s53, s53, s40
    s_lshl_b32 s45, s43, 15
    s_lshl_b32 s44, s40, 13
    s_add_u32 s45, s45, s44
    s_add_u32 s45, s45, 10551296
    s_add_u32 s47, s45, 4096
    s_mul_i32 s41, s43, 57344
    s_lshl_b32 s42, s53, 6
    s_add_u32 s41, s41, s42
    s_add_u32 s41, s41, 896
    s_lshl_b32 s42, s43, 11
    s_add_u32 s52, s52, s42
    s_lshl_b32 s42, s40, 9
    s_add_u32 s52, s52, s42
    s_add_u32 s52, s52, 589824
    v_and_b32 v249, 3, v0
    v_lshlrev_b32 v249, 7, v249
    v_lshrrev_b32 v15, 5, v0
    v_and_b32 v14, 31, v0
    v_mul_u32_u24 v250, 1792, v14
    v_lshl_add_u32 v250, v15, 4, v250
    v_lshrrev_b32 v251, 3, v0
    v_lshlrev_b32 v251, 17, v251
    v_and_b32 v13, 7, v0
    v_lshl_add_u32 v251, v13, 4, v251
    v_bfe_u32 v9, v0, 2, 2
    v_and_b32 v10, 3, v0
    v_lshrrev_b32 v12, 1, v10
    v_and_b32 v10, 1, v10
    v_lshl_or_b32 v10, v10, 1, v12
    v_bfe_u32 v12, v0, 4, 1
    v_lshlrev_b32 v12, 5, v12
    v_lshl_or_b32 v10, v10, 3, v12
    s_lshl_b32 s42, s40, 6
    v_or_b32 v10, s42, v10
    v_mul_u32_u24 v12, 320, v9
    v_xor_b32 v252, v10, v12
    v_lshl_add_u32 v252, v15, 10, v252
    v_lshl_or_b32 v9, v15, 1, v9
    v_mul_u32_u24 v12, 320, v9
    v_xor_b32 v253, v10, v12
    v_add_u32 v254, 57344, v252
    v_add_u32 v255, 57344, v253
    v_mov_b32 v6, v8
    s_sub_u32 s60, s62, 2654435769
    v_lshrrev_b32 v12, 3, v0
    v_mul_u32_u24 v12, 131072, v12
    v_and_b32 v13, 7, v0
    v_lshl_add_u32 v12, v13, 4, v12
    v_mov_b32 v40, s60
    v_mov_b32 v41, s60
    v_mov_b32 v42, s60
    v_mov_b32 v43, s60
    s_bfm_b64 exec, 16, 0
    buffer_store_dwordx4 v[40:43], v12, s[36:39], s27 offen sc1
    s_mov_b64 exec, -1
    v_mov_b32 v112, 0
    v_mov_b32 v113, 0
    v_mov_b32 v114, 0
    v_mov_b32 v115, 0
    v_mov_b32 v116, 0
    v_mov_b32 v117, 0
    v_mov_b32 v118, 0
    v_mov_b32 v119, 0
    v_mov_b32 v120, 0
    v_mov_b32 v121, 0
    v_mov_b32 v122, 0
    v_mov_b32 v123, 0
    v_mov_b32 v124, 0
    v_mov_b32 v125, 0
    v_mov_b32 v126, 0
    v_mov_b32 v127, 0
    v_mov_b32 v128, 0
    v_mov_b32 v129, 0
    v_mov_b32 v130, 0
    v_mov_b32 v131, 0
    v_mov_b32 v132, 0
    v_mov_b32 v133, 0
    v_mov_b32 v134, 0
    v_mov_b32 v135, 0
    v_mov_b32 v136, 0
    v_mov_b32 v137, 0
    v_mov_b32 v138, 0
    v_mov_b32 v139, 0
    v_mov_b32 v140, 0
    v_mov_b32 v141, 0
    v_mov_b32 v142, 0
    v_mov_b32 v143, 0
    v_mov_b32 v144, 0
    v_mov_b32 v145, 0
    v_mov_b32 v146, 0
    v_mov_b32 v147, 0
    v_mov_b32 v148, 0
    v_mov_b32 v149, 0
    v_mov_b32 v150, 0
    v_mov_b32 v151, 0
    v_mov_b32 v152, 0
    v_mov_b32 v153, 0
    v_mov_b32 v154, 0
    v_mov_b32 v155, 0
    v_mov_b32 v156, 0
    v_mov_b32 v157, 0
    v_mov_b32 v158, 0
    v_mov_b32 v159, 0
    v_mov_b32 v160, 0
    v_mov_b32 v161, 0
    v_mov_b32 v162, 0
    v_mov_b32 v163, 0
    v_mov_b32 v164, 0
    v_mov_b32 v165, 0
    v_mov_b32 v166, 0
    v_mov_b32 v167, 0
    v_mov_b32 v168, 0
    v_mov_b32 v169, 0
    v_mov_b32 v170, 0
    v_mov_b32 v171, 0
    v_mov_b32 v172, 0
    v_mov_b32 v173, 0
    v_mov_b32 v174, 0
    v_mov_b32 v175, 0
    s_cmp_ge_u32 s51, 11
    s_cbranch_scc1 L_a1ld
    v_mov_b32 v12, 163116
lw_76:
    ds_read_b32 v13, v12
    s_waitcnt lgkmcnt(0)
    v_readfirstlane_b32 s60, v13
    s_nop 0
    s_cmp_ge_u32 s60, 1
    s_cbranch_scc1 lwd_77
    s_sleep 1
    s_branch lw_76
lwd_77:
    s_cmp_lg_u32 s51, 10
    s_cbranch_scc1 L_att2
L_att2:
    s_setprio 3
    v_mov_b32 v248, 162816
    v_mov_b32 v15, 1
    s_mov_b32 s61, 200000
spin_78:
    s_mov_b32 exec_lo, 0xffff
    buffer_load_dword v14, v11, s[36:39], s46 offen sc1
    s_waitcnt vmcnt(0)
    v_cmp_ne_u32 vcc, s62, v14
    s_nop 0
    s_cbranch_vccz spinok_79
    s_sub_u32 s61, s61, 1
    s_cmp_eq_u32 s61, 0
    s_cbranch_scc1 spinok_79
    s_sleep 1
    s_branch spin_78
spinok_79:
    s_mov_b64 exec, -1
    buffer_load_dwordx4 v[176:179], v1, s[36:39], s8 offen sc1
    buffer_load_dwordx4 v[16:19], v1, s[36:39], s50 offen sc1
    buffer_load_dwordx4 v[180:183], v2, s[36:39], s8 offen sc1
    buffer_load_dwordx4 v[20:23], v2, s[36:39], s50 offen sc1
    s_bfm_b64 exec, 16, 16
    buffer_load_dword v14, v11, s[36:39], s46 offen sc1
    s_mov_b64 exec, -1
lw_80:
    ds_read_b32 v13, v248 offset:252
    s_waitcnt lgkmcnt(0)
    v_readfirstlane_b32 s60, v13
    s_nop 0
    s_cmp_ge_u32 s60, 4
    s_cbranch_scc0 lw_80
    s_waitcnt vmcnt(0)
    v_mov_b32_dpp v22, v7 quad_perm:[0,1,2,3] row_mask:0xc bank_mask:0xf
    v_mov_b32_dpp v23, v7 quad_perm:[0,1,2,3] row_mask:0xc bank_mask:0xf
    v_mov_b32_dpp v182, v4 quad_perm:[0,1,2,3] row_mask:0xc bank_mask:0xf
    v_mfma_f32_32x32x16_bf16 v[64:79], v[176:179], v[16:19], 0
    s_nop 0
    v_mfma_f32_32x32x16_bf16 v[64:79], v[180:183], v[20:23], v[64:79]
    v_mfma_f32_32x32x16_bf16 v[48:63], v[176:179], v[16:19], 0
    ds_write_b128 v240, v[16:19]
    s_nop 9
    v_max3_f32 v8, v64, v65, v66
    v_max3_f32 v9, v67, v68, v69
    v_max3_f32 v8, v8, v70, v71
    v_max3_f32 v9, v9, v72, v73
    v_max3_f32 v8, v8, v74, v75
    v_max3_f32 v9, v9, v76, v77
    v_max3_f32 v8, v8, v78, v79
    v_max_f32 v8, v8, v9
    v_cvt_pk_bf16_f32 v8, -v8, v7
    s_nop 1
    v_mov_b32_dpp v22, v8 quad_perm:[0,1,2,3] row_mask:0xc bank_mask:0xf
    ds_write_b128 v240, v[20:23] offset:1024
    s_nop 0
    v_mfma_f32_32x32x16_bf16 v[48:63], v[180:183], v[20:23], v[48:63]
    s_mov_b64 exec, 1
    ds_add_u32 v248, v15 offset:236
    s_mov_b64 exec, -1
    s_bfm_b64 exec, 16, 16
    v_cmp_ne_u32 vcc, s62, v14
    s_mov_b64 exec, -1
    s_cbranch_vccz vok_82
    s_mov_b32 s61, 200000
spin_83:
    s_bfm_b64 exec, 16, 16
    buffer_load_dword v14, v11, s[36:39], s46 offen sc1
    s_waitcnt vmcnt(0)
    v_cmp_ne_u32 vcc, s62, v14
    s_nop 0
    s_cbranch_vccz spinok_84
    s_sub_u32 s61, s61, 1
    s_cmp_eq_u32 s61, 0
    s_cbranch_scc1 spinok_84
    s_sleep 1
    s_branch spin_83
spinok_84:
    s_mov_b64 exec, -1
vok_82:
    buffer_load_dwordx4 v[184:187], v3, s[36:39], s8 offen sc1
    buffer_load_dwordx4 v[188:191], v3, s[36:39], s8 offen offset:1024 sc1
    buffer_load_dwordx4 v[192:195], v1, s[36:39], s9 offen sc1
    buffer_load_dwordx4 v[196:199], v2, s[36:39], s9 offen sc1
    buffer_load_dwordx4 v[200:203], v3, s[36:39], s9 offen sc1
    buffer_load_dwordx4 v[204:207], v3, s[36:39], s9 offen offset:1024 sc1
    v_exp_f32 v48, v48
    v_exp_f32 v49, v49
    v_exp_f32 v50, v50
    v_exp_f32 v51, v51
    v_exp_f32 v52, v52
    v_exp_f32 v53, v53
    v_exp_f32 v54, v54
    v_exp_f32 v55, v55
    v_exp_f32 v56, v56
    v_exp_f32 v57, v57
    v_exp_f32 v58, v58
    v_exp_f32 v59, v59
lw_85:
    ds_read_b32 v13, v248 offset:236
    s_waitcnt lgkmcnt(0)
    v_readfirstlane_b32 s60, v13
    s_nop 0
    s_cmp_ge_u32 s60, 4
    s_cbranch_scc0 lw_85
    ds_read_b128 v[24:27], v241 offset:0
    ds_read_b128 v[28:31], v241 offset:1024
    ds_read_b128 v[32:35], v242 offset:0
    ds_read_b128 v[36:39], v242 offset:1024
    ds_read_b128 v[40:43], v243 offset:0
    ds_read_b128 v[44:47], v243 offset:1024
    s_waitcnt lgkmcnt(0)
    s_mov_b64 exec, 1
    ds_add_u32 v248, v15 offset:220
    s_mov_b64 exec, -1
    s_setprio 1
    v_mfma_f32_32x32x16_bf16 v[64:79], v[176:179], v[24:27], 0
    buffer_load_dwordx4 v[208:211], v1, s[36:39], s10 offen sc1
    buffer_load_dwordx4 v[212:215], v2, s[36:39], s10 offen sc1
    v_exp_f32 v60, v60
    v_mfma_f32_32x32x16_bf16 v[64:79], v[180:183], v[28:31], v[64:79]
    buffer_load_dwordx4 v[216:219], v3, s[36:39], s10 offen sc1
    buffer_load_dwordx4 v[220:223], v3, s[36:39], s10 offen offset:1024 sc1
    v_exp_f32 v61, v61
    v_exp_f32 v62, v62
    v_exp_f32 v63, v63
    v_mfma_f32_32x32x16_bf16 v[80:95], v[176:179], v[32:35], 0
    buffer_load_dwordx4 v[224:227], v1, s[36:39], s11 offen sc1
    s_nop 4
    v_exp_f32 v64, v64
    v_exp_f32 v65, v65
    v_exp_f32 v66, v66
    v_exp_f32 v67, v67
    v_mfma_f32_32x32x16_bf16 v[80:95], v[180:183], v[36:39], v[80:95]
    buffer_load_dwordx4 v[228:231], v2, s[36:39], s11 offen sc1
    v_exp_f32 v68, v68
    v_exp_f32 v69, v69
    v_exp_f32 v70, v70
    v_exp_f32 v71, v71
    v_exp_f32 v72, v72
    v_exp_f32 v73, v73
    v_exp_f32 v74, v74
    v_exp_f32 v75, v75
    v_exp_f32 v76, v76
    v_exp_f32 v77, v77
    v_exp_f32 v78, v78
    v_exp_f32 v79, v79
    v_mfma_f32_32x32x16_bf16 v[96:111], v[176:179], v[40:43], 0
    buffer_load_dwordx4 v[232:235], v3, s[36:39], s11 offen sc1
    v_exp_f32 v80, v80
    v_exp_f32 v81, v81
    v_exp_f32 v82, v82
    v_exp_f32 v83, v83
    v_mfma_f32_32x32x16_bf16 v[96:111], v[180:183], v[44:47], v[96:111]
    buffer_load_dwordx4 v[236:239], v3, s[36:39], s11 offen offset:1024 sc1
    v_exp_f32 v84, v84
    v_exp_f32 v85, v85
    v_exp_f32 v86, v86
    v_exp_f32 v87, v87
    s_waitcnt vmcnt(12)
    v_smfmac_f32_32x32x32_bf16 v[112:127], v[184:187], v[48:55], v5
    v_exp_f32 v88, v88
    v_exp_f32 v89, v89
    v_exp_f32 v90, v90
    v_exp_f32 v91, v91
    v_smfmac_f32_32x32x32_bf16 v[112:127], v[188:191], v[56:63], v5
    v_exp_f32 v92, v92
    v_exp_f32 v93, v93
    v_exp_f32 v94, v94
    v_exp_f32 v95, v95
    s_waitcnt vmcnt(8)
    v_mfma_f32_32x32x16_bf16 v[48:63], v[192:195], v[16:19], 0
    v_mov_b32_dpp v198, v4 quad_perm:[0,1,2,3] row_mask:0xc bank_mask:0xf
    v_exp_f32 v96, v96
    v_exp_f32 v97, v97
    v_exp_f32 v98, v98
    v_mfma_f32_32x32x16_bf16 v[48:63], v[196:199], v[20:23], v[48:63]
    v_exp_f32 v99, v99
    v_exp_f32 v100, v100
    v_exp_f32 v101, v101
    v_smfmac_f32_32x32x32_bf16 v[128:143], v[184:187], v[64:71], v5
    buffer_load_dwordx4 v[176:179], v1, s[36:39], s12 offen sc1
    v_exp_f32 v102, v102
    v_exp_f32 v103, v103
    v_exp_f32 v104, v104
    v_smfmac_f32_32x32x32_bf16 v[128:143], v[188:191], v[72:79], v5
    v_exp_f32 v105, v105
    v_exp_f32 v106, v106
    v_exp_f32 v107, v107
    v_smfmac_f32_32x32x32_bf16 v[144:159], v[184:187], v[80:87], v5
    v_exp_f32 v108, v108
    v_exp_f32 v109, v109
    v_exp_f32 v110, v110
    v_exp_f32 v111, v111
    v_mfma_f32_32x32x16_bf16 v[64:79], v[192:195], v[24:27], 0
    v_exp_f32 v48, v48
    v_exp_f32 v49, v49
    v_exp_f32 v50, v50
    v_mfma_f32_32x32x16_bf16 v[64:79], v[196:199], v[28:31], v[64:79]
    v_exp_f32 v51, v51
    v_exp_f32 v52, v52
    v_exp_f32 v53, v53
    v_smfmac_f32_32x32x32_bf16 v[144:159], v[188:191], v[88:95], v5
    buffer_load_dwordx4 v[180:183], v2, s[36:39], s12 offen sc1
    v_exp_f32 v54, v54
    v_exp_f32 v55, v55
    v_exp_f32 v56, v56
    v_smfmac_f32_32x32x32_bf16 v[160:175], v[184:187], v[96:103], v5
    v_exp_f32 v57, v57
    v_exp_f32 v58, v58
    v_exp_f32 v59, v59
    v_smfmac_f32_32x32x32_bf16 v[160:175], v[188:191], v[104:111], v5
    v_exp_f32 v60, v60
    v_exp_f32 v61, v61
    v_exp_f32 v62, v62
    v_exp_f32 v63, v63
    v_mfma_f32_32x32x16_bf16 v[80:95], v[192:195], v[32:35], 0
    v_exp_f32 v64, v64
    v_exp_f32 v65, v65
    v_exp_f32 v66, v66
    v_mfma_f32_32x32x16_bf16 v[80:95], v[196:199], v[36:39], v[80:95]
    v_exp_f32 v67, v67
    v_exp_f32 v68, v68
    v_exp_f32 v69, v69
    v_smfmac_f32_32x32x32_bf16 v[112:127], v[200:203], v[48:55], v5
    buffer_load_dwordx4 v[184:187], v3, s[36:39], s12 offen sc1
    v_exp_f32 v70, v70
    v_exp_f32 v71, v71
    v_exp_f32 v72, v72
    v_smfmac_f32_32x32x32_bf16 v[112:127], v[204:207], v[56:63], v5
    v_exp_f32 v73, v73
    v_exp_f32 v74, v74
    v_exp_f32 v75, v75
    v_smfmac_f32_32x32x32_bf16 v[128:143], v[200:203], v[64:71], v5
    v_exp_f32 v76, v76
    v_exp_f32 v77, v77
    v_exp_f32 v78, v78
    v_exp_f32 v79, v79
    v_mfma_f32_32x32x16_bf16 v[96:111], v[192:195], v[40:43], 0
    v_exp_f32 v80, v80
    v_exp_f32 v81, v81
    v_exp_f32 v82, v82
    v_exp_f32 v83, v83
    v_mfma_f32_32x32x16_bf16 v[96:111], v[196:199], v[44:47], v[96:111]
    v_exp_f32 v84, v84
    v_exp_f32 v85, v85
    v_exp_f32 v86, v86
    v_exp_f32 v87, v87
    v_smfmac_f32_32x32x32_bf16 v[128:143], v[204:207], v[72:79], v5
    buffer_load_dwordx4 v[188:191], v3, s[36:39], s12 offen offset:1024 sc1
    v_exp_f32 v88, v88
    v_exp_f32 v89, v89
    v_exp_f32 v90, v90
    v_exp_f32 v91, v91
    v_smfmac_f32_32x32x32_bf16 v[144:159], v[200:203], v[80:87], v5
    s_waitcnt vmcnt(8)
    v_exp_f32 v92, v92
    v_exp_f32 v93, v93
    v_exp_f32 v94, v94
    v_exp_f32 v95, v95
    v_mfma_f32_32x32x16_bf16 v[48:63], v[208:211], v[16:19], 0
    v_mov_b32_dpp v214, v4 quad_perm:[0,1,2,3] row_mask:0xc bank_mask:0xf
    v_exp_f32 v96, v96
    v_exp_f32 v97, v97
    v_exp_f32 v98, v98
    v_exp_f32 v99, v99
    v_mfma_f32_32x32x16_bf16 v[48:63], v[212:215], v[20:23], v[48:63]
    v_exp_f32 v100, v100
    v_exp_f32 v101, v101
    v_exp_f32 v102, v102
    v_exp_f32 v103, v103
    v_smfmac_f32_32x32x32_bf16 v[144:159], v[204:207], v[88:95], v5
    buffer_load_dwordx4 v[192:195], v1, s[36:39], s13 offen sc1
    v_exp_f32 v104, v104
    v_exp_f32 v105, v105
    v_exp_f32 v106, v106
    v_exp_f32 v107, v107
    v_smfmac_f32_32x32x32_bf16 v[160:175], v[200:203], v[96:103], v5
    v_exp_f32 v108, v108
    v_exp_f32 v109, v109
    v_exp_f32 v110, v110
    v_exp_f32 v111, v111
    v_mfma_f32_32x32x16_bf16 v[64:79], v[208:211], v[24:27], 0
    v_exp_f32 v48, v48
    v_exp_f32 v49, v49
    v_exp_f32 v50, v50
    v_exp_f32 v51, v51
    v_mfma_f32_32x32x16_bf16 v[64:79], v[212:215], v[28:31], v[64:79]
    v_exp_f32 v52, v52
    v_exp_f32 v53, v53
    v_exp_f32 v54, v54
    v_exp_f32 v55, v55
    v_smfmac_f32_32x32x32_bf16 v[160:175], v[204:207], v[104:111], v5
    buffer_load_dwordx4 v[196:199], v2, s[36:39], s13 offen sc1
    v_exp_f32 v56, v56
    v_exp_f32 v57, v57
    v_exp_f32 v58, v58
    v_exp_f32 v59, v59
    v_smfmac_f32_32x32x32_bf16 v[112:127], v[216:219], v[48:55], v5
    v_exp_f32 v60, v60
    v_exp_f32 v61, v61
    v_exp_f32 v62, v62
    v_exp_f32 v63, v63
    v_mfma_f32_32x32x16_bf16 v[80:95], v[208:211], v[32:35], 0
    v_exp_f32 v64, v64
    v_exp_f32 v65, v65
    v_exp_f32 v66, v66
    v_exp_f32 v67, v67
    v_mfma_f32_32x32x16_bf16 v[80:95], v[212:215], v[36:39], v[80:95]
    v_exp_f32 v68, v68
    v_exp_f32 v69, v69
    v_exp_f32 v70, v70
    v_exp_f32 v71, v71
    v_smfmac_f32_32x32x32_bf16 v[112:127], v[220:223], v[56:63], v5
    buffer_load_dwordx4 v[200:203], v3, s[36:39], s13 offen sc1
    v_exp_f32 v72, v72
    v_exp_f32 v73, v73
    v_exp_f32 v74, v74
    v_exp_f32 v75, v75
    v_smfmac_f32_32x32x32_bf16 v[128:143], v[216:219], v[64:71], v5
    v_exp_f32 v76, v76
    v_exp_f32 v77, v77
    v_exp_f32 v78, v78
    v_exp_f32 v79, v79
    v_mfma_f32_32x32x16_bf16 v[96:111], v[208:211], v[40:43], 0
    v_exp_f32 v80, v80
    v_exp_f32 v81, v81
    v_exp_f32 v82, v82
    v_exp_f32 v83, v83
    v_mfma_f32_32x32x16_bf16 v[96:111], v[212:215], v[44:47], v[96:111]
    v_exp_f32 v84, v84
    v_exp_f32 v85, v85
    v_exp_f32 v86, v86
    v_exp_f32 v87, v87
    v_smfmac_f32_32x32x32_bf16 v[128:143], v[220:223], v[72:79], v5
    buffer_load_dwordx4 v[204:207], v3, s[36:39], s13 offen offset:1024 sc1
    v_exp_f32 v88, v88
    v_exp_f32 v89, v89
    v_exp_f32 v90, v90
    v_exp_f32 v91, v91
    v_smfmac_f32_32x32x32_bf16 v[144:159], v[216:219], v[80:87], v5
    s_waitcnt vmcnt(8)
    v_exp_f32 v92, v92
    v_exp_f32 v93, v93
    v_exp_f32 v94, v94
    v_exp_f32 v95, v95
    v_mfma_f32_32x32x16_bf16 v[48:63], v[224:227], v[16:19], 0
    v_mov_b32_dpp v230, v4 quad_perm:[0,1,2,3] row_mask:0xc bank_mask:0xf
    v_exp_f32 v96, v96
    v_exp_f32 v97, v97
    v_exp_f32 v98, v98
    v_exp_f32 v99, v99
    v_mfma_f32_32x32x16_bf16 v[48:63], v[228:231], v[20:23], v[48:63]
    v_exp_f32 v100, v100
    v_exp_f32 v101, v101
    v_exp_f32 v102, v102
    v_exp_f32 v103, v103
    v_smfmac_f32_32x32x32_bf16 v[144:159], v[220:223], v[88:95], v5
    buffer_load_dwordx4 v[208:211], v1, s[36:39], s14 offen sc1
    v_exp_f32 v104, v104
    v_exp_f32 v105, v105
    v_exp_f32 v106, v106
    v_exp_f32 v107, v107
    v_smfmac_f32_32x32x32_bf16 v[160:175], v[216:219], v[96:103], v5
    v_exp_f32 v108, v108
    v_exp_f32 v109, v109
    v_exp_f32 v110, v110
    v_exp_f32 v111, v111
    v_mfma_f32_32x32x16_bf16 v[64:79], v[224:227], v[24:27], 0
    v_exp_f32 v48, v48
    v_exp_f32 v49, v49
    v_exp_f32 v50, v50
    v_exp_f32 v51, v51
    v_mfma_f32_32x32x16_bf16 v[64:79], v[228:231], v[28:31], v[64:79]
    v_exp_f32 v52, v52
    v_exp_f32 v53, v53
    v_exp_f32 v54, v54
    v_exp_f32 v55, v55
    v_smfmac_f32_32x32x32_bf16 v[160:175], v[220:223], v[104:111], v5
    buffer_load_dwordx4 v[212:215], v2, s[36:39], s14 offen sc1
    v_exp_f32 v56, v56
    v_exp_f32 v57, v57
    v_exp_f32 v58, v58
    v_exp_f32 v59, v59
    v_smfmac_f32_32x32x32_bf16 v[112:127], v[232:235], v[48:55], v5
    v_exp_f32 v60, v60
    v_exp_f32 v61, v61
    v_exp_f32 v62, v62
    v_exp_f32 v63, v63
    v_mfma_f32_32x32x16_bf16 v[80:95], v[224:227], v[32:35], 0
    v_exp_f32 v64, v64
    v_exp_f32 v65, v65
    v_exp_f32 v66, v66
    v_exp_f32 v67, v67
    v_mfma_f32_32x32x16_bf16 v[80:95], v[228:231], v[36:39], v[80:95]
    v_exp_f32 v68, v68
    v_exp_f32 v69, v69
    v_exp_f32 v70, v70
    v_exp_f32 v71, v71
    v_smfmac_f32_32x32x32_bf16 v[112:127], v[236:239], v[56:63], v5
    buffer_load_dwordx4 v[216:219], v3, s[36:39], s14 offen sc1
    v_exp_f32 v72, v72
    v_exp_f32 v73, v73
    v_exp_f32 v74, v74
    v_exp_f32 v75, v75
    v_smfmac_f32_32x32x32_bf16 v[128:143], v[232:235], v[64:71], v5
    v_exp_f32 v76, v76
    v_exp_f32 v77, v77
    v_exp_f32 v78, v78
    v_exp_f32 v79, v79
    v_mfma_f32_32x32x16_bf16 v[96:111], v[224:227], v[40:43], 0
    v_exp_f32 v80, v80
    v_exp_f32 v81, v81
    v_exp_f32 v82, v82
    v_exp_f32 v83, v83
    v_mfma_f32_32x32x16_bf16 v[96:111], v[228:231], v[44:47], v[96:111]
    v_exp_f32 v84, v84
    v_exp_f32 v85, v85
    v_exp_f32 v86, v86
    v_exp_f32 v87, v87
    v_smfmac_f32_32x32x32_bf16 v[128:143], v[236:239], v[72:79], v5
    buffer_load_dwordx4 v[220:223], v3, s[36:39], s14 offen offset:1024 sc1
    v_exp_f32 v88, v88
    v_exp_f32 v89, v89
    v_exp_f32 v90, v90
    v_exp_f32 v91, v91
    v_smfmac_f32_32x32x32_bf16 v[144:159], v[232:235], v[80:87], v5
    s_waitcnt vmcnt(8)
    v_exp_f32 v92, v92
    v_exp_f32 v93, v93
    v_exp_f32 v94, v94
    v_exp_f32 v95, v95
    v_mfma_f32_32x32x16_bf16 v[48:63], v[176:179], v[16:19], 0
    v_mov_b32_dpp v182, v4 quad_perm:[0,1,2,3] row_mask:0xc bank_mask:0xf
    v_exp_f32 v96, v96
    v_exp_f32 v97, v97
    v_exp_f32 v98, v98
    v_exp_f32 v99, v99
    v_mfma_f32_32x32x16_bf16 v[48:63], v[180:183], v[20:23], v[48:63]
    v_exp_f32 v100, v100
    v_exp_f32 v101, v101
    v_exp_f32 v102, v102
    v_exp_f32 v103, v103
    v_smfmac_f32_32x32x32_bf16 v[144:159], v[236:239], v[88:95], v5
    buffer_load_dwordx4 v[224:227], v1, s[36:39], s15 offen sc1
    v_exp_f32 v104, v104
    v_exp_f32 v105, v105
    v_exp_f32 v106, v106
    v_exp_f32 v107, v107
    v_smfmac_f32_32x32x32_bf16 v[160:175], v[232:235], v[96:103], v5
    v_exp_f32 v108, v108
    v_exp_f32 v109, v109
    v_exp_f32 v110, v110
    v_exp_f32 v111, v111
    v_mfma_f32_32x32x16_bf16 v[64:79], v[176:179], v[24:27], 0
    v_exp_f32 v48, v48
    v_exp_f32 v49, v49
    v_exp_f32 v50, v50
    v_exp_f32 v51, v51
    v_mfma_f32_32x32x16_bf16 v[64:79], v[180:183], v[28:31], v[64:79]
    v_exp_f32 v52, v52
    v_exp_f32 v53, v53
    v_exp_f32 v54, v54
    v_exp_f32 v55, v55
    v_smfmac_f32_32x32x32_bf16 v[160:175], v[236:239], v[104:111], v5
    buffer_load_dwordx4 v[228:231], v2, s[36:39], s15 offen sc1
    v_exp_f32 v56, v56
    v_exp_f32 v57, v57
    v_exp_f32 v58, v58
    v_exp_f32 v59, v59
    v_smfmac_f32_32x32x32_bf16 v[112:127], v[184:187], v[48:55], v5
    v_exp_f32 v60, v60
    v_exp_f32 v61, v61
    v_exp_f32 v62, v62
    v_exp_f32 v63, v63
    v_mfma_f32_32x32x16_bf16 v[80:95], v[176:179], v[32:35], 0
    v_exp_f32 v64, v64
    v_exp_f32 v65, v65
    v_exp_f32 v66, v66
    v_exp_f32 v67, v67
    v_mfma_f32_32x32x16_bf16 v[80:95], v[180:183], v[36:39], v[80:95]
    v_exp_f32 v68, v68
    v_exp_f32 v69, v69
    v_exp_f32 v70, v70
    v_exp_f32 v71, v71
    v_smfmac_f32_32x32x32_bf16 v[112:127], v[188:191], v[56:63], v5
    buffer_load_dwordx4 v[232:235], v3, s[36:39], s15 offen sc1
    v_exp_f32 v72, v72
    v_exp_f32 v73, v73
    v_exp_f32 v74, v74
    v_exp_f32 v75, v75
    v_smfmac_f32_32x32x32_bf16 v[128:143], v[184:187], v[64:71], v5
    v_exp_f32 v76, v76
    v_exp_f32 v77, v77
    v_exp_f32 v78, v78
    v_exp_f32 v79, v79
    v_mfma_f32_32x32x16_bf16 v[96:111], v[176:179], v[40:43], 0
    v_exp_f32 v80, v80
    v_exp_f32 v81, v81
    v_exp_f32 v82, v82
    v_exp_f32 v83, v83
    v_mfma_f32_32x32x16_bf16 v[96:111], v[180:183], v[44:47], v[96:111]
    v_exp_f32 v84, v84
    v_exp_f32 v85, v85
    v_exp_f32 v86, v86
    v_exp_f32 v87, v87
    v_smfmac_f32_32x32x32_bf16 v[128:143], v[188:191], v[72:79], v5
    buffer_load_dwordx4 v[236:239], v3, s[36:39], s15 offen offset:1024 sc1
    v_exp_f32 v88, v88
    v_exp_f32 v89, v89
    v_exp_f32 v90, v90
    v_exp_f32 v91, v91
    v_smfmac_f32_32x32x32_bf16 v[144:159], v[184:187], v[80:87], v5
    s_waitcnt vmcnt(8)
    v_exp_f32 v92, v92
    v_exp_f32 v93, v93
    v_exp_f32 v94, v94
    v_exp_f32 v95, v95
    v_mfma_f32_32x32x16_bf16 v[48:63], v[192:195], v[16:19], 0
    v_mov_b32_dpp v198, v4 quad_perm:[0,1,2,3] row_mask:0xc bank_mask:0xf
    v_exp_f32 v96, v96
    v_exp_f32 v97, v97
    v_exp_f32 v98, v98
    v_exp_f32 v99, v99
    v_mfma_f32_32x32x16_bf16 v[48:63], v[196:199], v[20:23], v[48:63]
    v_exp_f32 v100, v100
    v_exp_f32 v101, v101
    v_exp_f32 v102, v102
    v_exp_f32 v103, v103
    v_smfmac_f32_32x32x32_bf16 v[144:159], v[188:191], v[88:95], v5
    buffer_load_dwordx4 v[176:179], v1, s[36:39], s16 offen sc1
    v_exp_f32 v104, v104
    v_exp_f32 v105, v105
    v_exp_f32 v106, v106
    v_exp_f32 v107, v107
    v_smfmac_f32_32x32x32_bf16 v[160:175], v[184:187], v[96:103], v5
    v_exp_f32 v108, v108
    v_exp_f32 v109, v109
    v_exp_f32 v110, v110
    v_exp_f32 v111, v111
    v_mfma_f32_32x32x16_bf16 v[64:79], v[192:195], v[24:27], 0
    v_exp_f32 v48, v48
    v_exp_f32 v49, v49
    v_exp_f32 v50, v50
    v_exp_f32 v51, v51
    v_mfma_f32_32x32x16_bf16 v[64:79], v[196:199], v[28:31], v[64:79]
    v_exp_f32 v52, v52
    v_exp_f32 v53, v53
    v_exp_f32 v54, v54
    v_exp_f32 v55, v55
    v_smfmac_f32_32x32x32_bf16 v[160:175], v[188:191], v[104:111], v5
    buffer_load_dwordx4 v[180:183], v2, s[36:39], s16 offen sc1
    v_exp_f32 v56, v56
    v_exp_f32 v57, v57
    v_exp_f32 v58, v58
    v_exp_f32 v59, v59
    v_smfmac_f32_32x32x32_bf16 v[112:127], v[200:203], v[48:55], v5
    v_exp_f32 v60, v60
    v_exp_f32 v61, v61
    v_exp_f32 v62, v62
    v_exp_f32 v63, v63
    v_mfma_f32_32x32x16_bf16 v[80:95], v[192:195], v[32:35], 0
    v_exp_f32 v64, v64
    v_exp_f32 v65, v65
    v_exp_f32 v66, v66
    v_exp_f32 v67, v67
    v_mfma_f32_32x32x16_bf16 v[80:95], v[196:199], v[36:39], v[80:95]
    v_exp_f32 v68, v68
    v_exp_f32 v69, v69
    v_exp_f32 v70, v70
    v_exp_f32 v71, v71
    v_smfmac_f32_32x32x32_bf16 v[112:127], v[204:207], v[56:63], v5
    buffer_load_dwordx4 v[184:187], v3, s[36:39], s16 offen sc1
    v_exp_f32 v72, v72
    v_exp_f32 v73, v73
    v_exp_f32 v74, v74
    v_exp_f32 v75, v75
    v_smfmac_f32_32x32x32_bf16 v[128:143], v[200:203], v[64:71], v5
    v_exp_f32 v76, v76
    v_exp_f32 v77, v77
    v_exp_f32 v78, v78
    v_exp_f32 v79, v79
    v_mfma_f32_32x32x16_bf16 v[96:111], v[192:195], v[40:43], 0
    v_exp_f32 v80, v80
    v_exp_f32 v81, v81
    v_exp_f32 v82, v82
    v_exp_f32 v83, v83
    v_mfma_f32_32x32x16_bf16 v[96:111], v[196:199], v[44:47], v[96:111]
    v_exp_f32 v84, v84
    v_exp_f32 v85, v85
    v_exp_f32 v86, v86
    v_exp_f32 v87, v87
    v_smfmac_f32_32x32x32_bf16 v[128:143], v[204:207], v[72:79], v5
    buffer_load_dwordx4 v[188:191], v3, s[36:39], s16 offen offset:1024 sc1
    v_exp_f32 v88, v88
    v_exp_f32 v89, v89
    v_exp_f32 v90, v90
    v_exp_f32 v91, v91
    v_smfmac_f32_32x32x32_bf16 v[144:159], v[200:203], v[80:87], v5
    s_waitcnt vmcnt(8)
    v_exp_f32 v92, v92
    v_exp_f32 v93, v93
    v_exp_f32 v94, v94
    v_exp_f32 v95, v95
    v_mfma_f32_32x32x16_bf16 v[48:63], v[208:211], v[16:19], 0
    v_mov_b32_dpp v214, v4 quad_perm:[0,1,2,3] row_mask:0xc bank_mask:0xf
    v_exp_f32 v96, v96
    v_exp_f32 v97, v97
    v_exp_f32 v98, v98
    v_exp_f32 v99, v99
    v_mfma_f32_32x32x16_bf16 v[48:63], v[212:215], v[20:23], v[48:63]
    v_exp_f32 v100, v100
    v_exp_f32 v101, v101
    v_exp_f32 v102, v102
    v_exp_f32 v103, v103
    v_smfmac_f32_32x32x32_bf16 v[144:159], v[204:207], v[88:95], v5
    buffer_load_dwordx4 v[192:195], v1, s[36:39], s17 offen sc1
    v_exp_f32 v104, v104
    v_exp_f32 v105, v105
    v_exp_f32 v106, v106
    v_exp_f32 v107, v107
    v_smfmac_f32_32x32x32_bf16 v[160:175], v[200:203], v[96:103], v5
    v_exp_f32 v108, v108
    v_exp_f32 v109, v109
    v_exp_f32 v110, v110
    v_exp_f32 v111, v111
    v_mfma_f32_32x32x16_bf16 v[64:79], v[208:211], v[24:27], 0
    v_exp_f32 v48, v48
    v_exp_f32 v49, v49
    v_exp_f32 v50, v50
    v_exp_f32 v51, v51
    v_mfma_f32_32x32x16_bf16 v[64:79], v[212:215], v[28:31], v[64:79]
    v_exp_f32 v52, v52
    v_exp_f32 v53, v53
    v_exp_f32 v54, v54
    v_exp_f32 v55, v55
    v_smfmac_f32_32x32x32_bf16 v[160:175], v[204:207], v[104:111], v5
    buffer_load_dwordx4 v[196:199], v2, s[36:39], s17 offen sc1
    v_exp_f32 v56, v56
    v_exp_f32 v57, v57
    v_exp_f32 v58, v58
    v_exp_f32 v59, v59
    v_smfmac_f32_32x32x32_bf16 v[112:127], v[216:219], v[48:55], v5
    v_exp_f32 v60, v60
    v_exp_f32 v61, v61
    v_exp_f32 v62, v62
    v_exp_f32 v63, v63
    v_mfma_f32_32x32x16_bf16 v[80:95], v[208:211], v[32:35], 0
    v_exp_f32 v64, v64
    v_exp_f32 v65, v65
    v_exp_f32 v66, v66
    v_exp_f32 v67, v67
    v_mfma_f32_32x32x16_bf16 v[80:95], v[212:215], v[36:39], v[80:95]
    v_exp_f32 v68, v68
    v_exp_f32 v69, v69
    v_exp_f32 v70, v70
    v_exp_f32 v71, v71
    v_smfmac_f32_32x32x32_bf16 v[112:127], v[220:223], v[56:63], v5
    buffer_load_dwordx4 v[200:203], v3, s[36:39], s17 offen sc1
    v_exp_f32 v72, v72
    v_exp_f32 v73, v73
    v_exp_f32 v74, v74
    v_exp_f32 v75, v75
    v_smfmac_f32_32x32x32_bf16 v[128:143], v[216:219], v[64:71], v5
    v_exp_f32 v76, v76
    v_exp_f32 v77, v77
    v_exp_f32 v78, v78
    v_exp_f32 v79, v79
    v_mfma_f32_32x32x16_bf16 v[96:111], v[208:211], v[40:43], 0
    v_exp_f32 v80, v80
    v_exp_f32 v81, v81
    v_exp_f32 v82, v82
    v_exp_f32 v83, v83
    v_mfma_f32_32x32x16_bf16 v[96:111], v[212:215], v[44:47], v[96:111]
    v_exp_f32 v84, v84
    v_exp_f32 v85, v85
    v_exp_f32 v86, v86
    v_exp_f32 v87, v87
    v_smfmac_f32_32x32x32_bf16 v[128:143], v[220:223], v[72:79], v5
    buffer_load_dwordx4 v[204:207], v3, s[36:39], s17 offen offset:1024 sc1
    v_exp_f32 v88, v88
    v_exp_f32 v89, v89
    v_exp_f32 v90, v90
    v_exp_f32 v91, v91
    v_smfmac_f32_32x32x32_bf16 v[144:159], v[216:219], v[80:87], v5
    s_waitcnt vmcnt(8)
    v_exp_f32 v92, v92
    v_exp_f32 v93, v93
    v_exp_f32 v94, v94
    v_exp_f32 v95, v95
    v_mfma_f32_32x32x16_bf16 v[48:63], v[224:227], v[16:19], 0
    v_mov_b32_dpp v230, v4 quad_perm:[0,1,2,3] row_mask:0xc bank_mask:0xf
    v_exp_f32 v96, v96
    v_exp_f32 v97, v97
    v_exp_f32 v98, v98
    v_exp_f32 v99, v99
    v_mfma_f32_32x32x16_bf16 v[48:63], v[228:231], v[20:23], v[48:63]
    v_exp_f32 v100, v100
    v_exp_f32 v101, v101
    v_exp_f32 v102, v102
    v_exp_f32 v103, v103
    v_smfmac_f32_32x32x32_bf16 v[144:159], v[220:223], v[88:95], v5
    buffer_load_dwordx4 v[208:211], v1, s[36:39], s18 offen sc1
    v_exp_f32 v104, v104
    v_exp_f32 v105, v105
    v_exp_f32 v106, v106
    v_exp_f32 v107, v107
    v_smfmac_f32_32x32x32_bf16 v[160:175], v[216:219], v[96:103], v5
    v_exp_f32 v108, v108
    v_exp_f32 v109, v109
    v_exp_f32 v110, v110
    v_exp_f32 v111, v111
    v_mfma_f32_32x32x16_bf16 v[64:79], v[224:227], v[24:27], 0
    v_exp_f32 v48, v48
    v_exp_f32 v49, v49
    v_exp_f32 v50, v50
    v_exp_f32 v51, v51
    v_mfma_f32_32x32x16_bf16 v[64:79], v[228:231], v[28:31], v[64:79]
    v_exp_f32 v52, v52
    v_exp_f32 v53, v53
    v_exp_f32 v54, v54
    v_exp_f32 v55, v55
    v_smfmac_f32_32x32x32_bf16 v[160:175], v[220:223], v[104:111], v5
    buffer_load_dwordx4 v[212:215], v2, s[36:39], s18 offen sc1
    v_exp_f32 v56, v56
    v_exp_f32 v57, v57
    v_exp_f32 v58, v58
    v_exp_f32 v59, v59
    v_smfmac_f32_32x32x32_bf16 v[112:127], v[232:235], v[48:55], v5
    v_exp_f32 v60, v60
    v_exp_f32 v61, v61
    v_exp_f32 v62, v62
    v_exp_f32 v63, v63
    v_mfma_f32_32x32x16_bf16 v[80:95], v[224:227], v[32:35], 0
    v_exp_f32 v64, v64
    v_exp_f32 v65, v65
    v_exp_f32 v66, v66
    v_exp_f32 v67, v67
    v_mfma_f32_32x32x16_bf16 v[80:95], v[228:231], v[36:39], v[80:95]
    v_exp_f32 v68, v68
    v_exp_f32 v69, v69
    v_exp_f32 v70, v70
    v_exp_f32 v71, v71
    v_smfmac_f32_32x32x32_bf16 v[112:127], v[236:239], v[56:63], v5
    buffer_load_dwordx4 v[216:219], v3, s[36:39], s18 offen sc1
    v_exp_f32 v72, v72
    v_exp_f32 v73, v73
    v_exp_f32 v74, v74
    v_exp_f32 v75, v75
    v_smfmac_f32_32x32x32_bf16 v[128:143], v[232:235], v[64:71], v5
    v_exp_f32 v76, v76
    v_exp_f32 v77, v77
    v_exp_f32 v78, v78
    v_exp_f32 v79, v79
    v_mfma_f32_32x32x16_bf16 v[96:111], v[224:227], v[40:43], 0
    v_exp_f32 v80, v80
    v_exp_f32 v81, v81
    v_exp_f32 v82, v82
    v_exp_f32 v83, v83
    v_mfma_f32_32x32x16_bf16 v[96:111], v[228:231], v[44:47], v[96:111]
    v_exp_f32 v84, v84
    v_exp_f32 v85, v85
    v_exp_f32 v86, v86
    v_exp_f32 v87, v87
    v_smfmac_f32_32x32x32_bf16 v[128:143], v[236:239], v[72:79], v5
    buffer_load_dwordx4 v[220:223], v3, s[36:39], s18 offen offset:1024 sc1
    v_exp_f32 v88, v88
    v_exp_f32 v89, v89
    v_exp_f32 v90, v90
    v_exp_f32 v91, v91
    v_smfmac_f32_32x32x32_bf16 v[144:159], v[232:235], v[80:87], v5
    s_waitcnt vmcnt(8)
    v_exp_f32 v92, v92
    v_exp_f32 v93, v93
    v_exp_f32 v94, v94
    v_exp_f32 v95, v95
    v_mfma_f32_32x32x16_bf16 v[48:63], v[176:179], v[16:19], 0
    v_mov_b32_dpp v182, v4 quad_perm:[0,1,2,3] row_mask:0xc bank_mask:0xf
    v_exp_f32 v96, v96
    v_exp_f32 v97, v97
    v_exp_f32 v98, v98
    v_exp_f32 v99, v99
    v_mfma_f32_32x32x16_bf16 v[48:63], v[180:183], v[20:23], v[48:63]
    v_exp_f32 v100, v100
    v_exp_f32 v101, v101
    v_exp_f32 v102, v102
    v_exp_f32 v103, v103
    v_smfmac_f32_32x32x32_bf16 v[144:159], v[236:239], v[88:95], v5
    buffer_load_dwordx4 v[224:227], v1, s[36:39], s19 offen sc1
    v_exp_f32 v104, v104
    v_exp_f32 v105, v105
    v_exp_f32 v106, v106
    v_exp_f32 v107, v107
    v_smfmac_f32_32x32x32_bf16 v[160:175], v[232:235], v[96:103], v5
    v_exp_f32 v108, v108
    v_exp_f32 v109, v109
    v_exp_f32 v110, v110
    v_exp_f32 v111, v111
    v_mfma_f32_32x32x16_bf16 v[64:79], v[176:179], v[24:27], 0
    v_exp_f32 v48, v48
    v_exp_f32 v49, v49
    v_exp_f32 v50, v50
    v_exp_f32 v51, v51
    v_mfma_f32_32x32x16_bf16 v[64:79], v[180:183], v[28:31], v[64:79]
    v_exp_f32 v52, v52
    v_exp_f32 v53, v53
    v_exp_f32 v54, v54
    v_exp_f32 v55, v55
    v_smfmac_f32_32x32x32_bf16 v[160:175], v[236:239], v[104:111], v5
    buffer_load_dwordx4 v[228:231], v2, s[36:39], s19 offen sc1
    v_exp_f32 v56, v56
    v_exp_f32 v57, v57
    v_exp_f32 v58, v58
    v_exp_f32 v59, v59
    v_smfmac_f32_32x32x32_bf16 v[112:127], v[184:187], v[48:55], v5
    v_exp_f32 v60, v60
    v_exp_f32 v61, v61
    v_exp_f32 v62, v62
    v_exp_f32 v63, v63
    v_mfma_f32_32x32x16_bf16 v[80:95], v[176:179], v[32:35], 0
    v_exp_f32 v64, v64
    v_exp_f32 v65, v65
    v_exp_f32 v66, v66
    v_exp_f32 v67, v67
    v_mfma_f32_32x32x16_bf16 v[80:95], v[180:183], v[36:39], v[80:95]
    v_exp_f32 v68, v68
    v_exp_f32 v69, v69
    v_exp_f32 v70, v70
    v_exp_f32 v71, v71
    v_smfmac_f32_32x32x32_bf16 v[112:127], v[188:191], v[56:63], v5
    buffer_load_dwordx4 v[232:235], v3, s[36:39], s19 offen sc1
    v_exp_f32 v72, v72
    v_exp_f32 v73, v73
    v_exp_f32 v74, v74
    v_exp_f32 v75, v75
    v_smfmac_f32_32x32x32_bf16 v[128:143], v[184:187], v[64:71], v5
    v_exp_f32 v76, v76
    v_exp_f32 v77, v77
    v_exp_f32 v78, v78
    v_exp_f32 v79, v79
    v_mfma_f32_32x32x16_bf16 v[96:111], v[176:179], v[40:43], 0
    v_exp_f32 v80, v80
    v_exp_f32 v81, v81
    v_exp_f32 v82, v82
    v_exp_f32 v83, v83
    v_mfma_f32_32x32x16_bf16 v[96:111], v[180:183], v[44:47], v[96:111]
    v_exp_f32 v84, v84
    v_exp_f32 v85, v85
    v_exp_f32 v86, v86
    v_exp_f32 v87, v87
    v_smfmac_f32_32x32x32_bf16 v[128:143], v[188:191], v[72:79], v5
    buffer_load_dwordx4 v[236:239], v3, s[36:39], s19 offen offset:1024 sc1
    v_exp_f32 v88, v88
    v_exp_f32 v89, v89
    v_exp_f32 v90, v90
    v_exp_f32 v91, v91
    v_smfmac_f32_32x32x32_bf16 v[144:159], v[184:187], v[80:87], v5
    s_waitcnt vmcnt(8)
    v_exp_f32 v92, v92
    v_exp_f32 v93, v93
    v_exp_f32 v94, v94
    v_exp_f32 v95, v95
    v_mfma_f32_32x32x16_bf16 v[48:63], v[192:195], v[16:19], 0
    v_mov_b32_dpp v198, v4 quad_perm:[0,1,2,3] row_mask:0xc bank_mask:0xf
    v_exp_f32 v96, v96
    v_exp_f32 v97, v97
    v_exp_f32 v98, v98
    v_exp_f32 v99, v99
    v_mfma_f32_32x32x16_bf16 v[48:63], v[196:199], v[20:23], v[48:63]
    v_exp_f32 v100, v100
    v_exp_f32 v101, v101
    v_exp_f32 v102, v102
    v_exp_f32 v103, v103
    v_smfmac_f32_32x32x32_bf16 v[144:159], v[188:191], v[88:95], v5
    buffer_load_dwordx4 v[176:179], v1, s[36:39], s20 offen sc1
    v_exp_f32 v104, v104
    v_exp_f32 v105, v105
    v_exp_f32 v106, v106
    v_exp_f32 v107, v107
    v_smfmac_f32_32x32x32_bf16 v[160:175], v[184:187], v[96:103], v5
    v_exp_f32 v108, v108
    v_exp_f32 v109, v109
    v_exp_f32 v110, v110
    v_exp_f32 v111, v111
    v_mfma_f32_32x32x16_bf16 v[64:79], v[192:195], v[24:27], 0
    v_exp_f32 v48, v48
    v_exp_f32 v49, v49
    v_exp_f32 v50, v50
    v_exp_f32 v51, v51
    v_mfma_f32_32x32x16_bf16 v[64:79], v[196:199], v[28:31], v[64:79]
    v_exp_f32 v52, v52
    v_exp_f32 v53, v53
    v_exp_f32 v54, v54
    v_exp_f32 v55, v55
    v_smfmac_f32_32x32x32_bf16 v[160:175], v[188:191], v[104:111], v5
    buffer_load_dwordx4 v[180:183], v2, s[36:39], s20 offen sc1
    v_exp_f32 v56, v56
    v_exp_f32 v57, v57
    v_exp_f32 v58, v58
    v_exp_f32 v59, v59
    v_smfmac_f32_32x32x32_bf16 v[112:127], v[200:203], v[48:55], v5
    v_exp_f32 v60, v60
    v_exp_f32 v61, v61
    v_exp_f32 v62, v62
    v_exp_f32 v63, v63
    v_mfma_f32_32x32x16_bf16 v[80:95], v[192:195], v[32:35], 0
    v_exp_f32 v64, v64
    v_exp_f32 v65, v65
    v_exp_f32 v66, v66
    v_exp_f32 v67, v67
    v_mfma_f32_32x32x16_bf16 v[80:95], v[196:199], v[36:39], v[80:95]
    v_exp_f32 v68, v68
    v_exp_f32 v69, v69
    v_exp_f32 v70, v70
    v_exp_f32 v71, v71
    v_smfmac_f32_32x32x32_bf16 v[112:127], v[204:207], v[56:63], v5
    buffer_load_dwordx4 v[184:187], v3, s[36:39], s20 offen sc1
    v_exp_f32 v72, v72
    v_exp_f32 v73, v73
    v_exp_f32 v74, v74
    v_exp_f32 v75, v75
    v_smfmac_f32_32x32x32_bf16 v[128:143], v[200:203], v[64:71], v5
    v_exp_f32 v76, v76
    v_exp_f32 v77, v77
    v_exp_f32 v78, v78
    v_exp_f32 v79, v79
    v_mfma_f32_32x32x16_bf16 v[96:111], v[192:195], v[40:43], 0
    v_exp_f32 v80, v80
    v_exp_f32 v81, v81
    v_exp_f32 v82, v82
    v_exp_f32 v83, v83
    v_mfma_f32_32x32x16_bf16 v[96:111], v[196:199], v[44:47], v[96:111]
    v_exp_f32 v84, v84
    v_exp_f32 v85, v85
    v_exp_f32 v86, v86
    v_exp_f32 v87, v87
    v_smfmac_f32_32x32x32_bf16 v[128:143], v[204:207], v[72:79], v5
    buffer_load_dwordx4 v[188:191], v3, s[36:39], s20 offen offset:1024 sc1
    v_exp_f32 v88, v88
    v_exp_f32 v89, v89
    v_exp_f32 v90, v90
    v_exp_f32 v91, v91
    v_smfmac_f32_32x32x32_bf16 v[144:159], v[200:203], v[80:87], v5
    s_waitcnt vmcnt(8)
    v_exp_f32 v92, v92
    v_exp_f32 v93, v93
    v_exp_f32 v94, v94
    v_exp_f32 v95, v95
    v_mfma_f32_32x32x16_bf16 v[48:63], v[208:211], v[16:19], 0
    v_mov_b32_dpp v214, v4 quad_perm:[0,1,2,3] row_mask:0xc bank_mask:0xf
    v_exp_f32 v96, v96
    v_exp_f32 v97, v97
    v_exp_f32 v98, v98
    v_exp_f32 v99, v99
    v_mfma_f32_32x32x16_bf16 v[48:63], v[212:215], v[20:23], v[48:63]
    v_exp_f32 v100, v100
    v_exp_f32 v101, v101
    v_exp_f32 v102, v102
    v_exp_f32 v103, v103
    v_smfmac_f32_32x32x32_bf16 v[144:159], v[204:207], v[88:95], v5
    buffer_load_dwordx4 v[192:195], v1, s[36:39], s21 offen sc1
    v_exp_f32 v104, v104
    v_exp_f32 v105, v105
    v_exp_f32 v106, v106
    v_exp_f32 v107, v107
    v_smfmac_f32_32x32x32_bf16 v[160:175], v[200:203], v[96:103], v5
    v_exp_f32 v108, v108
    v_exp_f32 v109, v109
    v_exp_f32 v110, v110
    v_exp_f32 v111, v111
    v_mfma_f32_32x32x16_bf16 v[64:79], v[208:211], v[24:27], 0
    v_exp_f32 v48, v48
    v_exp_f32 v49, v49
    v_exp_f32 v50, v50
    v_exp_f32 v51, v51
    v_mfma_f32_32x32x16_bf16 v[64:79], v[212:215], v[28:31], v[64:79]
    v_exp_f32 v52, v52
    v_exp_f32 v53, v53
    v_exp_f32 v54, v54
    v_exp_f32 v55, v55
    v_smfmac_f32_32x32x32_bf16 v[160:175], v[204:207], v[104:111], v5
    buffer_load_dwordx4 v[196:199], v2, s[36:39], s21 offen sc1
    v_exp_f32 v56, v56
    v_exp_f32 v57, v57
    v_exp_f32 v58, v58
    v_exp_f32 v59, v59
    v_smfmac_f32_32x32x32_bf16 v[112:127], v[216:219], v[48:55], v5
    v_exp_f32 v60, v60
    v_exp_f32 v61, v61
    v_exp_f32 v62, v62
    v_exp_f32 v63, v63
    v_mfma_f32_32x32x16_bf16 v[80:95], v[208:211], v[32:35], 0
    v_exp_f32 v64, v64
    v_exp_f32 v65, v65
    v_exp_f32 v66, v66
    v_exp_f32 v67, v67
    v_mfma_f32_32x32x16_bf16 v[80:95], v[212:215], v[36:39], v[80:95]
    v_exp_f32 v68, v68
    v_exp_f32 v69, v69
    v_exp_f32 v70, v70
    v_exp_f32 v71, v71
    v_smfmac_f32_32x32x32_bf16 v[112:127], v[220:223], v[56:63], v5
    buffer_load_dwordx4 v[200:203], v3, s[36:39], s21 offen sc1
    v_exp_f32 v72, v72
    v_exp_f32 v73, v73
    v_exp_f32 v74, v74
    v_exp_f32 v75, v75
    v_smfmac_f32_32x32x32_bf16 v[128:143], v[216:219], v[64:71], v5
    v_exp_f32 v76, v76
    v_exp_f32 v77, v77
    v_exp_f32 v78, v78
    v_exp_f32 v79, v79
    v_mfma_f32_32x32x16_bf16 v[96:111], v[208:211], v[40:43], 0
    v_exp_f32 v80, v80
    v_exp_f32 v81, v81
    v_exp_f32 v82, v82
    v_exp_f32 v83, v83
    v_mfma_f32_32x32x16_bf16 v[96:111], v[212:215], v[44:47], v[96:111]
    v_exp_f32 v84, v84
    v_exp_f32 v85, v85
    v_exp_f32 v86, v86
    v_exp_f32 v87, v87
    v_smfmac_f32_32x32x32_bf16 v[128:143], v[220:223], v[72:79], v5
    buffer_load_dwordx4 v[204:207], v3, s[36:39], s21 offen offset:1024 sc1
    v_exp_f32 v88, v88
    v_exp_f32 v89, v89
    v_exp_f32 v90, v90
    v_exp_f32 v91, v91
    v_smfmac_f32_32x32x32_bf16 v[144:159], v[216:219], v[80:87], v5
    s_waitcnt vmcnt(8)
    v_exp_f32 v92, v92
    v_exp_f32 v93, v93
    v_exp_f32 v94, v94
    v_exp_f32 v95, v95
    v_mfma_f32_32x32x16_bf16 v[48:63], v[224:227], v[16:19], 0
    v_mov_b32_dpp v230, v4 quad_perm:[0,1,2,3] row_mask:0xc bank_mask:0xf
    v_exp_f32 v96, v96
    v_exp_f32 v97, v97
    v_exp_f32 v98, v98
    v_exp_f32 v99, v99
    v_mfma_f32_32x32x16_bf16 v[48:63], v[228:231], v[20:23], v[48:63]
    v_exp_f32 v100, v100
    v_exp_f32 v101, v101
    v_exp_f32 v102, v102
    v_exp_f32 v103, v103
    v_smfmac_f32_32x32x32_bf16 v[144:159], v[220:223], v[88:95], v5
    buffer_load_dwordx4 v[208:211], v1, s[36:39], s22 offen sc1
    v_exp_f32 v104, v104
    v_exp_f32 v105, v105
    v_exp_f32 v106, v106
    v_exp_f32 v107, v107
    v_smfmac_f32_32x32x32_bf16 v[160:175], v[216:219], v[96:103], v5
    v_exp_f32 v108, v108
    v_exp_f32 v109, v109
    v_exp_f32 v110, v110
    v_exp_f32 v111, v111
    v_mfma_f32_32x32x16_bf16 v[64:79], v[224:227], v[24:27], 0
    v_exp_f32 v48, v48
    v_exp_f32 v49, v49
    v_exp_f32 v50, v50
    v_exp_f32 v51, v51
    v_mfma_f32_32x32x16_bf16 v[64:79], v[228:231], v[28:31], v[64:79]
    v_exp_f32 v52, v52
    v_exp_f32 v53, v53
    v_exp_f32 v54, v54
    v_exp_f32 v55, v55
    v_smfmac_f32_32x32x32_bf16 v[160:175], v[220:223], v[104:111], v5
    buffer_load_dwordx4 v[212:215], v2, s[36:39], s22 offen sc1
    v_exp_f32 v56, v56
    v_exp_f32 v57, v57
    v_exp_f32 v58, v58
    v_exp_f32 v59, v59
    v_smfmac_f32_32x32x32_bf16 v[112:127], v[232:235], v[48:55], v5
    v_exp_f32 v60, v60
    v_exp_f32 v61, v61
    v_exp_f32 v62, v62
    v_exp_f32 v63, v63
    v_mfma_f32_32x32x16_bf16 v[80:95], v[224:227], v[32:35], 0
    v_exp_f32 v64, v64
    v_exp_f32 v65, v65
    v_exp_f32 v66, v66
    v_exp_f32 v67, v67
    v_mfma_f32_32x32x16_bf16 v[80:95], v[228:231], v[36:39], v[80:95]
    v_exp_f32 v68, v68
    v_exp_f32 v69, v69
    v_exp_f32 v70, v70
    v_exp_f32 v71, v71
    v_smfmac_f32_32x32x32_bf16 v[112:127], v[236:239], v[56:63], v5
    buffer_load_dwordx4 v[216:219], v3, s[36:39], s22 offen sc1
    v_exp_f32 v72, v72
    v_exp_f32 v73, v73
    v_exp_f32 v74, v74
    v_exp_f32 v75, v75
    v_smfmac_f32_32x32x32_bf16 v[128:143], v[232:235], v[64:71], v5
    v_exp_f32 v76, v76
    v_exp_f32 v77, v77
    v_exp_f32 v78, v78
    v_exp_f32 v79, v79
    v_mfma_f32_32x32x16_bf16 v[96:111], v[224:227], v[40:43], 0
    v_exp_f32 v80, v80
    v_exp_f32 v81, v81
    v_exp_f32 v82, v82
    v_exp_f32 v83, v83
    v_mfma_f32_32x32x16_bf16 v[96:111], v[228:231], v[44:47], v[96:111]
    v_exp_f32 v84, v84
    v_exp_f32 v85, v85
    v_exp_f32 v86, v86
    v_exp_f32 v87, v87
    v_smfmac_f32_32x32x32_bf16 v[128:143], v[236:239], v[72:79], v5
    buffer_load_dwordx4 v[220:223], v3, s[36:39], s22 offen offset:1024 sc1
    v_exp_f32 v88, v88
    v_exp_f32 v89, v89
    v_exp_f32 v90, v90
    v_exp_f32 v91, v91
    v_smfmac_f32_32x32x32_bf16 v[144:159], v[232:235], v[80:87], v5
    s_waitcnt vmcnt(8)
    v_exp_f32 v92, v92
    v_exp_f32 v93, v93
    v_exp_f32 v94, v94
    v_exp_f32 v95, v95
    v_mfma_f32_32x32x16_bf16 v[48:63], v[176:179], v[16:19], 0
    v_mov_b32_dpp v182, v4 quad_perm:[0,1,2,3] row_mask:0xc bank_mask:0xf
    v_exp_f32 v96, v96
    v_exp_f32 v97, v97
    v_exp_f32 v98, v98
    v_exp_f32 v99, v99
    v_mfma_f32_32x32x16_bf16 v[48:63], v[180:183], v[20:23], v[48:63]
    v_exp_f32 v100, v100
    v_exp_f32 v101, v101
    v_exp_f32 v102, v102
    v_exp_f32 v103, v103
    v_smfmac_f32_32x32x32_bf16 v[144:159], v[236:239], v[88:95], v5
    buffer_load_dwordx4 v[224:227], v1, s[36:39], s23 offen sc1
    v_exp_f32 v104, v104
    v_exp_f32 v105, v105
    v_exp_f32 v106, v106
    v_exp_f32 v107, v107
    v_smfmac_f32_32x32x32_bf16 v[160:175], v[232:235], v[96:103], v5
    v_exp_f32 v108, v108
    v_exp_f32 v109, v109
    v_exp_f32 v110, v110
    v_exp_f32 v111, v111
    v_mfma_f32_32x32x16_bf16 v[64:79], v[176:179], v[24:27], 0
    v_exp_f32 v48, v48
    v_exp_f32 v49, v49
    v_exp_f32 v50, v50
    v_exp_f32 v51, v51
    v_mfma_f32_32x32x16_bf16 v[64:79], v[180:183], v[28:31], v[64:79]
    v_exp_f32 v52, v52
    v_exp_f32 v53, v53
    v_exp_f32 v54, v54
    v_exp_f32 v55, v55
    v_smfmac_f32_32x32x32_bf16 v[160:175], v[236:239], v[104:111], v5
    buffer_load_dwordx4 v[228:231], v2, s[36:39], s23 offen sc1
    v_exp_f32 v56, v56
    v_exp_f32 v57, v57
    v_exp_f32 v58, v58
    v_exp_f32 v59, v59
    v_smfmac_f32_32x32x32_bf16 v[112:127], v[184:187], v[48:55], v5
    v_exp_f32 v60, v60
    v_exp_f32 v61, v61
    v_exp_f32 v62, v62
    v_exp_f32 v63, v63
    v_mfma_f32_32x32x16_bf16 v[80:95], v[176:179], v[32:35], 0
    v_exp_f32 v64, v64
    v_exp_f32 v65, v65
    v_exp_f32 v66, v66
    v_exp_f32 v67, v67
    v_mfma_f32_32x32x16_bf16 v[80:95], v[180:183], v[36:39], v[80:95]
    v_exp_f32 v68, v68
    v_exp_f32 v69, v69
    v_exp_f32 v70, v70
    v_exp_f32 v71, v71
    v_smfmac_f32_32x32x32_bf16 v[112:127], v[188:191], v[56:63], v5
    buffer_load_dwordx4 v[232:235], v3, s[36:39], s23 offen sc1
    v_exp_f32 v72, v72
    v_exp_f32 v73, v73
    v_exp_f32 v74, v74
    v_exp_f32 v75, v75
    v_smfmac_f32_32x32x32_bf16 v[128:143], v[184:187], v[64:71], v5
    s_waitcnt vmcnt(7)
    v_exp_f32 v76, v76
    v_exp_f32 v77, v77
    v_exp_f32 v78, v78
    v_exp_f32 v79, v79
    v_mfma_f32_32x32x16_bf16 v[96:111], v[192:195], v[16:19], 0
    v_mov_b32_dpp v198, v4 quad_perm:[0,1,2,3] row_mask:0xc bank_mask:0xf
    v_exp_f32 v80, v80
    v_exp_f32 v81, v81
    v_exp_f32 v82, v82
    v_exp_f32 v83, v83
    v_mfma_f32_32x32x16_bf16 v[96:111], v[196:199], v[20:23], v[96:111]
    v_exp_f32 v84, v84
    v_exp_f32 v85, v85
    v_exp_f32 v86, v86
    v_exp_f32 v87, v87
    v_smfmac_f32_32x32x32_bf16 v[128:143], v[188:191], v[72:79], v5
    buffer_load_dwordx4 v[236:239], v3, s[36:39], s23 offen offset:1024 sc1
    v_exp_f32 v88, v88
    v_exp_f32 v89, v89
    v_exp_f32 v90, v90
    v_exp_f32 v91, v91
    v_smfmac_f32_32x32x32_bf16 v[144:159], v[184:187], v[80:87], v5
    s_waitcnt vmcnt(6)
    v_exp_f32 v92, v92
    v_exp_f32 v93, v93
    v_exp_f32 v94, v94
    v_exp_f32 v95, v95
    v_mfma_f32_32x32x16_bf16 v[48:63], v[208:211], v[16:19], 0
    v_mov_b32_dpp v214, v4 quad_perm:[0,1,2,3] row_mask:0xc bank_mask:0xf
    v_exp_f32 v96, v96
    v_exp_f32 v97, v97
    v_exp_f32 v98, v98
    v_exp_f32 v99, v99
    v_mfma_f32_32x32x16_bf16 v[48:63], v[212:215], v[20:23], v[48:63]
    v_exp_f32 v100, v100
    v_exp_f32 v101, v101
    v_exp_f32 v102, v102
    v_exp_f32 v103, v103
    v_smfmac_f32_32x32x32_bf16 v[144:159], v[188:191], v[88:95], v5
    v_exp_f32 v104, v104
    v_exp_f32 v105, v105
    v_exp_f32 v106, v106
    v_exp_f32 v107, v107
    v_smfmac_f32_32x32x32_bf16 v[112:127], v[200:203], v[96:103], v5
    s_waitcnt vmcnt(2)
    v_exp_f32 v108, v108
    v_exp_f32 v109, v109
    v_exp_f32 v110, v110
    v_exp_f32 v111, v111
    v_mfma_f32_32x32x16_bf16 v[64:79], v[224:227], v[16:19], 0
    v_mov_b32_dpp v230, v4 quad_perm:[0,1,2,3] row_mask:0xc bank_mask:0xf
    v_exp_f32 v48, v48
    v_exp_f32 v49, v49
    v_exp_f32 v50, v50
    v_exp_f32 v51, v51
    v_mfma_f32_32x32x16_bf16 v[64:79], v[228:231], v[20:23], v[64:79]
    v_exp_f32 v52, v52
    v_exp_f32 v53, v53
    v_exp_f32 v54, v54
    v_exp_f32 v55, v55
    v_smfmac_f32_32x32x32_bf16 v[112:127], v[204:207], v[104:111], v5
    v_exp_f32 v56, v56
    v_exp_f32 v57, v57
    v_exp_f32 v58, v58
    v_exp_f32 v59, v59
    v_smfmac_f32_32x32x32_bf16 v[112:127], v[216:219], v[48:55], v5
    v_exp_f32 v60, v60
    v_exp_f32 v61, v61
    v_exp_f32 v62, v62
    v_exp_f32 v63, v63
    v_mfma_f32_32x32x16_bf16 v[80:95], v[192:195], v[24:27], 0
    v_exp_f32 v64, v64
    v_exp_f32 v65, v65
    v_exp_f32 v66, v66
    v_exp_f32 v67, v67
    v_mfma_f32_32x32x16_bf16 v[80:95], v[196:199], v[28:31], v[80:95]
    v_exp_f32 v68, v68
    v_exp_f32 v69, v69
    v_exp_f32 v70, v70
    v_exp_f32 v71, v71
    v_smfmac_f32_32x32x32_bf16 v[112:127], v[220:223], v[56:63], v5
    s_waitcnt vmcnt(0)
    v_exp_f32 v72, v72
    v_exp_f32 v73, v73
    v_exp_f32 v74, v74
    v_exp_f32 v75, v75
    v_smfmac_f32_32x32x32_bf16 v[112:127], v[232:235], v[64:71], v5
    v_exp_f32 v76, v76
    v_exp_f32 v77, v77
    v_exp_f32 v78, v78
    v_exp_f32 v79, v79
    v_mfma_f32_32x32x16_bf16 v[96:111], v[208:211], v[24:27], 0
    v_exp_f32 v80, v80
    v_exp_f32 v81, v81
    v_exp_f32 v82, v82
    v_exp_f32 v83, v83
    v_mfma_f32_32x32x16_bf16 v[96:111], v[212:215], v[28:31], v[96:111]
    v_exp_f32 v84, v84
    v_exp_f32 v85, v85
    v_exp_f32 v86, v86
    v_exp_f32 v87, v87
    v_smfmac_f32_32x32x32_bf16 v[112:127], v[236:239], v[72:79], v5
    v_exp_f32 v88, v88
    v_exp_f32 v89, v89
    v_exp_f32 v90, v90
    v_exp_f32 v91, v91
    v_smfmac_f32_32x32x32_bf16 v[128:143], v[200:203], v[80:87], v5
    v_exp_f32 v92, v92
    v_exp_f32 v93, v93
    v_exp_f32 v94, v94
    v_exp_f32 v95, v95
    v_mfma_f32_32x32x16_bf16 v[48:63], v[224:227], v[24:27], 0
    v_exp_f32 v96, v96
    v_exp_f32 v97, v97
    v_exp_f32 v98, v98
    v_exp_f32 v99, v99
    v_mfma_f32_32x32x16_bf16 v[48:63], v[228:231], v[28:31], v[48:63]
    ds_write_b128 v244, v[112:115] offset:0
    v_exp_f32 v100, v100
    v_exp_f32 v101, v101
    v_exp_f32 v102, v102
    v_exp_f32 v103, v103
    v_smfmac_f32_32x32x32_bf16 v[128:143], v[204:207], v[88:95], v5
    ds_write_b128 v244, v[116:119] offset:1024
    v_exp_f32 v104, v104
    v_exp_f32 v105, v105
    v_exp_f32 v106, v106
    v_exp_f32 v107, v107
    v_smfmac_f32_32x32x32_bf16 v[128:143], v[216:219], v[96:103], v5
    ds_write_b128 v244, v[120:123] offset:2048
    v_exp_f32 v108, v108
    v_exp_f32 v109, v109
    v_exp_f32 v110, v110
    v_exp_f32 v111, v111
    v_mfma_f32_32x32x16_bf16 v[64:79], v[192:195], v[32:35], 0
    ds_write_b96 v244, v[124:126] offset:3072
    v_exp_f32 v48, v48
    v_exp_f32 v49, v49
    v_exp_f32 v50, v50
    v_exp_f32 v51, v51
    v_mfma_f32_32x32x16_bf16 v[64:79], v[196:199], v[36:39], v[64:79]
    v_exp_f32 v52, v52
    v_exp_f32 v53, v53
    v_exp_f32 v54, v54
    v_exp_f32 v55, v55
    v_smfmac_f32_32x32x32_bf16 v[128:143], v[220:223], v[104:111], v5
    v_exp_f32 v56, v56
    v_exp_f32 v57, v57
    v_exp_f32 v58, v58
    v_exp_f32 v59, v59
    v_smfmac_f32_32x32x32_bf16 v[128:143], v[232:235], v[48:55], v5
    v_exp_f32 v60, v60
    v_exp_f32 v61, v61
    v_exp_f32 v62, v62
    v_exp_f32 v63, v63
    v_mfma_f32_32x32x16_bf16 v[80:95], v[208:211], v[32:35], 0
    v_exp_f32 v64, v64
    v_exp_f32 v65, v65
    v_exp_f32 v66, v66
    v_exp_f32 v67, v67
    v_mfma_f32_32x32x16_bf16 v[80:95], v[212:215], v[36:39], v[80:95]
    v_exp_f32 v68, v68
    v_exp_f32 v69, v69
    v_exp_f32 v70, v70
    v_exp_f32 v71, v71
    v_smfmac_f32_32x32x32_bf16 v[128:143], v[236:239], v[56:63], v5
    v_exp_f32 v72, v72
    v_exp_f32 v73, v73
    v_exp_f32 v74, v74
    v_exp_f32 v75, v75
    v_smfmac_f32_32x32x32_bf16 v[144:159], v[200:203], v[64:71], v5
    v_exp_f32 v76, v76
    v_exp_f32 v77, v77
    v_exp_f32 v78, v78
    v_exp_f32 v79, v79
    v_mfma_f32_32x32x16_bf16 v[96:111], v[224:227], v[32:35], 0
    v_exp_f32 v80, v80
    v_exp_f32 v81, v81
    v_exp_f32 v82, v82
    v_exp_f32 v83, v83
    v_mfma_f32_32x32x16_bf16 v[96:111], v[228:231], v[36:39], v[96:111]
    ds_write_b128 v245, v[128:131] offset:0
    v_exp_f32 v84, v84
    v_exp_f32 v85, v85
    v_exp_f32 v86, v86
    v_exp_f32 v87, v87
    v_smfmac_f32_32x32x32_bf16 v[144:159], v[204:207], v[72:79], v5
    ds_write_b128 v245, v[132:135] offset:1024
    v_exp_f32 v88, v88
    v_exp_f32 v89, v89
    v_exp_f32 v90, v90
    v_exp_f32 v91, v91
    v_smfmac_f32_32x32x32_bf16 v[144:159], v[216:219], v[80:87], v5
    ds_write_b128 v245, v[136:139] offset:2048
    v_exp_f32 v92, v92
    v_exp_f32 v93, v93
    v_exp_f32 v94, v94
    v_exp_f32 v95, v95
    v_mfma_f32_32x32x16_bf16 v[48:63], v[176:179], v[40:43], 0
    ds_write_b96 v245, v[140:142] offset:3072
    v_exp_f32 v96, v96
    v_exp_f32 v97, v97
    v_exp_f32 v98, v98
    v_exp_f32 v99, v99
    v_mfma_f32_32x32x16_bf16 v[48:63], v[180:183], v[44:47], v[48:63]
    v_exp_f32 v100, v100
    v_exp_f32 v101, v101
    v_exp_f32 v102, v102
    v_exp_f32 v103, v103
    v_smfmac_f32_32x32x32_bf16 v[144:159], v[220:223], v[88:95], v5
    v_exp_f32 v104, v104
    v_exp_f32 v105, v105
    v_exp_f32 v106, v106
    v_exp_f32 v107, v107
    v_smfmac_f32_32x32x32_bf16 v[144:159], v[232:235], v[96:103], v5
    v_exp_f32 v108, v108
    v_exp_f32 v109, v109
    v_exp_f32 v110, v110
    v_exp_f32 v111, v111
    v_mfma_f32_32x32x16_bf16 v[64:79], v[192:195], v[40:43], 0
    v_exp_f32 v48, v48
    v_exp_f32 v49, v49
    v_exp_f32 v50, v50
    v_exp_f32 v51, v51
    v_mfma_f32_32x32x16_bf16 v[64:79], v[196:199], v[44:47], v[64:79]
    v_exp_f32 v52, v52
    v_exp_f32 v53, v53
    v_exp_f32 v54, v54
    v_exp_f32 v55, v55
    v_smfmac_f32_32x32x32_bf16 v[144:159], v[236:239], v[104:111], v5
    v_exp_f32 v56, v56
    v_exp_f32 v57, v57
    v_exp_f32 v58, v58
    v_exp_f32 v59, v59
    v_smfmac_f32_32x32x32_bf16 v[160:175], v[184:187], v[48:55], v5
    v_exp_f32 v60, v60
    v_exp_f32 v61, v61
    v_exp_f32 v62, v62
    v_exp_f32 v63, v63
    v_mfma_f32_32x32x16_bf16 v[80:95], v[208:211], v[40:43], 0
    v_exp_f32 v64, v64
    v_exp_f32 v65, v65
    v_exp_f32 v66, v66
    v_exp_f32 v67, v67
    v_mfma_f32_32x32x16_bf16 v[80:95], v[212:215], v[44:47], v[80:95]
    ds_write_b128 v246, v[144:147] offset:0
    v_exp_f32 v68, v68
    v_exp_f32 v69, v69
    v_exp_f32 v70, v70
    v_exp_f32 v71, v71
    v_smfmac_f32_32x32x32_bf16 v[160:175], v[188:191], v[56:63], v5
    ds_write_b128 v246, v[148:151] offset:1024
    v_exp_f32 v72, v72
    v_exp_f32 v73, v73
    v_exp_f32 v74, v74
    v_exp_f32 v75, v75
    v_smfmac_f32_32x32x32_bf16 v[160:175], v[200:203], v[64:71], v5
    ds_write_b128 v246, v[152:155] offset:2048
    v_exp_f32 v76, v76
    v_exp_f32 v77, v77
    v_exp_f32 v78, v78
    v_exp_f32 v79, v79
    v_mfma_f32_32x32x16_bf16 v[96:111], v[224:227], v[40:43], 0
    ds_write_b96 v246, v[156:158] offset:3072
    s_mov_b64 exec, 1
    ds_add_u32 v248, v15 offset:44
    s_mov_b64 exec, -1
    v_exp_f32 v80, v80
    v_exp_f32 v81, v81
    v_exp_f32 v82, v82
    v_exp_f32 v83, v83
    v_mfma_f32_32x32x16_bf16 v[96:111], v[228:231], v[44:47], v[96:111]
    v_exp_f32 v84, v84
    v_exp_f32 v85, v85
    v_exp_f32 v86, v86
    v_exp_f32 v87, v87
    v_smfmac_f32_32x32x32_bf16 v[160:175], v[204:207], v[72:79], v5
    v_exp_f32 v88, v88
    v_exp_f32 v89, v89
    v_exp_f32 v90, v90
    v_exp_f32 v91, v91
    v_smfmac_f32_32x32x32_bf16 v[160:175], v[216:219], v[80:87], v5
    v_exp_f32 v92, v92
    v_exp_f32 v93, v93
    v_exp_f32 v94, v94
    v_exp_f32 v95, v95
    v_exp_f32 v96, v96
    v_exp_f32 v97, v97
    v_exp_f32 v98, v98
    v_exp_f32 v99, v99
    v_smfmac_f32_32x32x32_bf16 v[160:175], v[220:223], v[88:95], v5
    ds_read_b32 v13, v248 offset:44
    ds_read_b128 v[112:115], v247 offset:0
    ds_read_b128 v[116:119], v247 offset:1024
    ds_read_b128 v[120:123], v247 offset:2048
    ds_read_b128 v[124:127], v247 offset:3072
    v_exp_f32 v100, v100
    v_exp_f32 v101, v101
    v_exp_f32 v102, v102
    v_exp_f32 v103, v103
    ds_read_b128 v[128:131], v247 offset:4096
    ds_read_b128 v[132:135], v247 offset:5120
    ds_read_b128 v[136:139], v247 offset:6144
    ds_read_b128 v[140:143], v247 offset:7168
    v_exp_f32 v104, v104
    v_exp_f32 v105, v105
    v_exp_f32 v106, v106
    v_exp_f32 v107, v107
    v_smfmac_f32_32x32x32_bf16 v[160:175], v[232:235], v[96:103], v5
    ds_read_b128 v[144:147], v247 offset:8192
    ds_read_b128 v[148:151], v247 offset:9216
    ds_read_b128 v[152:155], v247 offset:10240
    ds_read_b128 v[156:159], v247 offset:11264
    v_exp_f32 v108, v108
    v_exp_f32 v109, v109
    v_exp_f32 v110, v110
    v_exp_f32 v111, v111
    s_nop 1
    v_smfmac_f32_32x32x32_bf16 v[160:175], v[236:239], v[104:111], v5
    s_setprio 3
    s_waitcnt lgkmcnt(12)
    v_readfirstlane_b32 s60, v13
    s_nop 0
    s_cmp_ge_u32 s60, 4
    s_cbranch_scc1 merged_87
lw_88:
    ds_read_b32 v13, v248 offset:44
    s_waitcnt lgkmcnt(0)
    v_readfirstlane_b32 s60, v13
    s_nop 0
    s_cmp_ge_u32 s60, 4
    s_cbranch_scc0 lw_88
    ds_read_b128 v[112:115], v247 offset:0
    ds_read_b128 v[116:119], v247 offset:1024
    ds_read_b128 v[120:123], v247 offset:2048
    ds_read_b128 v[124:127], v247 offset:3072
    ds_read_b128 v[128:131], v247 offset:4096
    ds_read_b128 v[132:135], v247 offset:5120
    ds_read_b128 v[136:139], v247 offset:6144
    ds_read_b128 v[140:143], v247 offset:7168
    ds_read_b128 v[144:147], v247 offset:8192
    ds_read_b128 v[148:151], v247 offset:9216
    ds_read_b128 v[152:155], v247 offset:10240
    ds_read_b128 v[156:159], v247 offset:11264
merged_87:
    s_waitcnt lgkmcnt(4)
    v_pk_add_f32 v[126:127], v[126:127], v[142:143]
    v_pk_add_f32 v[124:125], v[124:125], v[140:141]
    v_pk_add_f32 v[122:123], v[122:123], v[138:139]
    v_pk_add_f32 v[120:121], v[120:121], v[136:137]
    v_pk_add_f32 v[118:119], v[118:119], v[134:135]
    v_pk_add_f32 v[116:117], v[116:117], v[132:133]
    v_pk_add_f32 v[114:115], v[114:115], v[130:131]
    v_pk_add_f32 v[112:113], v[112:113], v[128:129]
    s_waitcnt lgkmcnt(0)
    v_pk_add_f32 v[126:127], v[126:127], v[158:159]
    v_pk_add_f32 v[124:125], v[124:125], v[156:157]
    v_pk_add_f32 v[122:123], v[122:123], v[154:155]
    v_pk_add_f32 v[120:121], v[120:121], v[152:153]
    v_pk_add_f32 v[118:119], v[118:119], v[150:151]
    v_pk_add_f32 v[116:117], v[116:117], v[148:149]
    v_pk_add_f32 v[114:115], v[114:115], v[146:147]
    v_pk_add_f32 v[112:113], v[112:113], v[144:145]
    v_pk_add_f32 v[174:175], v[174:175], v[126:127]
    v_pk_add_f32 v[172:173], v[172:173], v[124:125]
    v_pk_add_f32 v[170:171], v[170:171], v[122:123]
    v_pk_add_f32 v[168:169], v[168:169], v[120:121]
    v_pk_add_f32 v[166:167], v[166:167], v[118:119]
    v_pk_add_f32 v[164:165], v[164:165], v[116:117]
    v_pk_add_f32 v[162:163], v[162:163], v[114:115]
    v_pk_add_f32 v[160:161], v[160:161], v[112:113]
    v_cmp_nle_f32 vcc, 0x2b800000, v174
    s_nop 0
    s_mov_b64 s[48:49], vcc
    v_cmp_nge_f32 vcc, 0x53800000, v174
    s_nop 0
    s_or_b64 vcc, vcc, s[48:49]
    s_cbranch_vccnz L_fallback
L_norm:
    v_rcp_f32 v10, v174
    v_mov_b32 v55, 0
    v_mov_b32 v11, v10
    v_pk_mul_f32 v[160:161], v[160:161], v[10:11]
    v_cvt_pk_bf16_f32 v48, v160, v161
    v_pk_mul_f32 v[162:163], v[162:163], v[10:11]
    v_cvt_pk_bf16_f32 v49, v162, v163
    v_pk_mul_f32 v[164:165], v[164:165], v[10:11]
    v_cvt_pk_bf16_f32 v50, v164, v165
    v_pk_mul_f32 v[166:167], v[166:167], v[10:11]
    v_cvt_pk_bf16_f32 v51, v166, v167
    buffer_store_dwordx4 v[48:51], v6, s[36:39], s26 offen sc1
    v_pk_mul_f32 v[168:169], v[168:169], v[10:11]
    v_cvt_pk_bf16_f32 v52, v168, v169
    v_pk_mul_f32 v[170:171], v[170:171], v[10:11]
    v_cvt_pk_bf16_f32 v53, v170, v171
    v_pk_mul_f32 v[172:173], v[172:173], v[10:11]
    v_cvt_pk_bf16_f32 v54, v172, v173
    buffer_store_dwordx4 v[52:55], v6, s[36:39], s26 offen offset:1024 sc1
    s_mov_b64 exec, 1
    ds_add_u32 v248, v15 offset:204
    s_mov_b64 exec, -1
    v_bfe_u32 v9, v0, 2, 2
    v_mul_u32_u24 v10, 320, v9
    v_lshrrev_b32 v11, 5, v0
    v_lshl_add_u32 v10, v11, 10, v10
    v_xor_b32 v10, v252, v10
    v_cmp_gt_u32 vcc, 2, v9
    v_lshl_add_u32 v7, v11, 1, v9
    v_lshl_add_u32 v8, v11, 2, v9
    v_add_u32 v9, 24, v7
    v_add_u32 v11, 98, v8
    v_cndmask_b32 v11, v11, v9, vcc
    v_and_b32 v14, 3, v11
    v_lshlrev_b32 v14, 6, v14
    v_lshl_or_b32 v11, v11, 8, v14
    v_xor_b32 v16, v10, v11
    v_add_u32 v19, 57344, v16
    v_add_u32 v11, 72, v8
    v_cndmask_b32 v11, v11, v9, vcc
    v_and_b32 v14, 3, v11
    v_lshlrev_b32 v14, 6, v14
    v_lshl_or_b32 v11, v11, 8, v14
    v_xor_b32 v17, v10, v11
    v_add_u32 v20, 57344, v17
    v_add_u32 v11, 50, v7
    v_cndmask_b32 v11, v11, v9, vcc
    v_and_b32 v14, 3, v11
    v_lshlrev_b32 v14, 6, v14
    v_lshl_or_b32 v11, v11, 8, v14
    v_xor_b32 v18, v10, v11
    v_add_u32 v21, 57344, v18
    v_mov_b32 v40, s62
    v_mov_b32 v41, s62
    v_mov_b32 v42, s62
    v_mov_b32 v43, s62
lw_90:
    ds_read_b32 v13, v248 offset:172
    s_waitcnt lgkmcnt(0)
    v_readfirstlane_b32 s60, v13
    s_nop 0
    s_cmp_ge_u32 s60, 4
    s_cbranch_scc0 lw_90
    ds_read_b64_tr_b16 v[112:113], v252 offset:0
    ds_read_b64_tr_b16 v[114:115], v252 offset:2048
    ds_read_b64_tr_b16 v[116:117], v252 offset:4096
    ds_read_b64_tr_b16 v[118:119], v16 offset:0
    ds_read_b64_tr_b16 v[120:121], v252 offset:7168
    ds_read_b64_tr_b16 v[122:123], v252 offset:9216
    ds_read_b64_tr_b16 v[124:125], v252 offset:11264
    ds_read_b64_tr_b16 v[126:127], v17 offset:7168
    ds_read_b64_tr_b16 v[128:129], v252 offset:14336
    ds_read_b64_tr_b16 v[130:131], v252 offset:16384
    ds_read_b64_tr_b16 v[132:133], v252 offset:18432
    ds_read_b64_tr_b16 v[134:135], v18 offset:14336
    s_waitcnt lgkmcnt(2)
    ds_read_b64_tr_b16 v[136:137], v252 offset:21504
    ds_read_b64_tr_b16 v[138:139], v252 offset:23552
    ds_read_b64_tr_b16 v[144:145], v252 offset:28672
    ds_read_b64_tr_b16 v[146:147], v252 offset:30720
    ds_read_b64_tr_b16 v[148:149], v252 offset:32768
    ds_read_b64_tr_b16 v[150:151], v16 offset:28672
    ds_read_b64_tr_b16 v[152:153], v252 offset:35840
    ds_read_b64_tr_b16 v[154:155], v252 offset:37888
    ds_read_b64_tr_b16 v[156:157], v252 offset:39936
    ds_read_b64_tr_b16 v[158:159], v17 offset:35840
    ds_read_b64_tr_b16 v[160:161], v252 offset:43008
    ds_read_b64_tr_b16 v[162:163], v252 offset:45056
    s_waitcnt lgkmcnt(2)
    ds_read_b64_tr_b16 v[164:165], v252 offset:47104
    ds_read_b64_tr_b16 v[166:167], v18 offset:43008
    ds_read_b64_tr_b16 v[168:169], v252 offset:50176
    ds_read_b64_tr_b16 v[170:171], v252 offset:52224
    s_waitcnt lgkmcnt(2)
    s_bfm_b64 exec, 16, 0
    s_waitcnt vmcnt(0)
    buffer_store_dwordx4 v[40:43], v251, s[36:39], s27 offen sc1
    s_mov_b64 exec, -1
    ds_read_b64_tr_b16 v[176:177], v254 offset:0
    ds_read_b64_tr_b16 v[178:179], v254 offset:2048
    ds_read_b64_tr_b16 v[180:181], v254 offset:4096
    ds_read_b64_tr_b16 v[182:183], v19 offset:0
    ds_read_b64_tr_b16 v[184:185], v254 offset:7168
    ds_read_b64_tr_b16 v[186:187], v254 offset:9216
    ds_read_b64_tr_b16 v[188:189], v254 offset:11264
    ds_read_b64_tr_b16 v[190:191], v20 offset:7168
    ds_read_b64_tr_b16 v[192:193], v254 offset:14336
    ds_read_b64_tr_b16 v[194:195], v254 offset:16384
    ds_read_b64_tr_b16 v[196:197], v254 offset:18432
    ds_read_b64_tr_b16 v[198:199], v21 offset:14336
    s_waitcnt lgkmcnt(2)
    ds_read_b64_tr_b16 v[200:201], v254 offset:21504
    ds_read_b64_tr_b16 v[202:203], v254 offset:23552
    ds_read_b64_tr_b16 v[208:209], v254 offset:28672
    ds_read_b64_tr_b16 v[210:211], v254 offset:30720
    ds_read_b64_tr_b16 v[212:213], v254 offset:32768
    ds_read_b64_tr_b16 v[214:215], v19 offset:28672
    ds_read_b64_tr_b16 v[216:217], v254 offset:35840
    ds_read_b64_tr_b16 v[218:219], v254 offset:37888
    ds_read_b64_tr_b16 v[220:221], v254 offset:39936
    ds_read_b64_tr_b16 v[222:223], v20 offset:35840
    ds_read_b64_tr_b16 v[224:225], v254 offset:43008
    ds_read_b64_tr_b16 v[226:227], v254 offset:45056
    s_waitcnt lgkmcnt(2)
    ds_read_b64_tr_b16 v[228:229], v254 offset:47104
    ds_read_b64_tr_b16 v[230:231], v21 offset:43008
    ds_read_b64_tr_b16 v[232:233], v254 offset:50176
    ds_read_b64_tr_b16 v[234:235], v254 offset:52224
    s_mov_b64 exec, 1
    ds_add_rtn_u32 v13, v248, v15 offset:188
    s_mov_b64 exec, -1
    s_waitcnt lgkmcnt(0)
    v_readfirstlane_b32 s60, v13
    s_nop 0
    s_cmp_eq_u32 s60, 3
    s_cbranch_scc1 sy_92
lw_93:
    ds_read_b32 v13, v248 offset:188
    s_waitcnt lgkmcnt(0)
    v_readfirstlane_b32 s60, v13
    s_nop 0
    s_cmp_ge_u32 s60, 4
    s_cbranch_scc0 lw_93
sy_92:
    s_mov_b32 s61, 200000
spin_96:
    buffer_load_dword v14, v249, s[36:39], s52 offen sc1
    s_waitcnt vmcnt(0)
    v_cmp_ne_u32 vcc, s62, v14
    s_nop 0
    s_cbranch_vccz spinok_97
    s_sub_u32 s61, s61, 1
    s_cmp_eq_u32 s61, 0
    s_cbranch_scc1 spinok_97
    s_sleep 1
    s_branch spin_96
spinok_97:
oready_95:
    s_add_u32 m0, s44, 0
    s_nop 0
    buffer_load_dwordx4 v6, s[36:39], s45 offen offset:0 sc1 lds
    buffer_load_dwordx4 v6, s[36:39], s45 offen offset:1024 sc1 lds
    buffer_load_dwordx4 v6, s[36:39], s45 offen offset:2048 sc1 lds
    buffer_load_dwordx4 v6, s[36:39], s45 offen offset:3072 sc1 lds
    s_add_u32 m0, s44, 4096
    s_nop 0
    buffer_load_dwordx4 v6, s[36:39], s47 offen offset:0 sc1 lds
    buffer_load_dwordx4 v6, s[36:39], s47 offen offset:1024 sc1 lds
    buffer_load_dwordx4 v6, s[36:39], s47 offen offset:2048 sc1 lds
    buffer_load_dwordx4 v6, s[36:39], s47 offen offset:3072 sc1 lds
    s_lshl_b32 s42, s40, 11
    s_add_u32 s42, s42, 32768
    v_and_b32 v9, 31, v0
    v_lshrrev_b32 v10, 5, v0
    v_bfe_u32 v11, v0, 1, 2
    v_xor_b32 v10, v10, v11
    v_lshlrev_b32 v10, 4, v10
    v_lshl_or_b32 v1, v9, 6, v10
    v_add_u32 v1, s42, v1
    v_xor_b32 v2, 32, v1
    v_bfe_u32 v9, v0, 3, 2
    v_lshlrev_b32 v9, 4, v9
    v_xor_b32 v3, v6, v9
    v_add_u32 v3, s42, v3
    v_lshrrev_b32 v9, 2, v0
    v_mul_u32_u24 v9, 1792, v9
    v_and_b32 v10, 3, v0
    v_lshl_add_u32 v4, v10, 4, v9
    s_add_u32 s42, s41, 28672
    s_mov_b64 exec, 1
    s_waitcnt vmcnt(0)
    ds_add_rtn_u32 v13, v248, v15 offset:60
    s_mov_b64 exec, -1
    s_waitcnt lgkmcnt(0)
    v_readfirstlane_b32 s60, v13
    s_nop 0
    s_cmp_eq_u32 s60, 3
    s_cbranch_scc1 sy_98
lw_99:
    ds_read_b32 v13, v248 offset:60
    s_waitcnt lgkmcnt(0)
    v_readfirstlane_b32 s60, v13
    s_nop 0
    s_cmp_ge_u32 s60, 4
    s_cbranch_scc0 lw_99
sy_98:
    s_cmp_ge_u32 s53, 14
    s_cbranch_scc1 L_end
    ds_read_b128 v[96:99], v6 offset:7168
    ds_read_b128 v[68:71], v6 offset:0
    ds_read_b128 v[72:75], v6 offset:1024
    ds_read_b128 v[76:79], v6 offset:2048
    ds_read_b128 v[80:83], v6 offset:3072
    ds_read_b128 v[84:87], v6 offset:4096
    s_waitcnt lgkmcnt(4)
    v_mfma_f32_32x32x16_bf16 v[16:31], v[112:115], v[68:71], 0
    s_waitcnt lgkmcnt(3)
    v_mov_b32 v75, v96
    ds_read_b128 v[88:91], v6 offset:5120
    ds_read_b128 v[92:95], v6 offset:6144
    v_mfma_f32_32x32x16_bf16 v[16:31], v[116:119], v[72:75], v[16:31]
    s_waitcnt lgkmcnt(4)
    ds_read_b128 v[100:103], v6 offset:15360
    v_mfma_f32_32x32x16_bf16 v[16:31], v[120:123], v[76:79], v[16:31]
    s_waitcnt lgkmcnt(4)
    v_mov_b32 v83, v97
    ds_read_b128 v[68:71], v6 offset:8192
    s_nop 0
    v_mfma_f32_32x32x16_bf16 v[16:31], v[124:127], v[80:83], v[16:31]
    s_waitcnt lgkmcnt(4)
    ds_read_b128 v[72:75], v6 offset:9216
    v_mfma_f32_32x32x16_bf16 v[16:31], v[128:131], v[84:87], v[16:31]
    s_waitcnt lgkmcnt(4)
    v_mov_b32 v91, v98
    ds_read_b128 v[76:79], v6 offset:10240
    s_nop 0
    v_mfma_f32_32x32x16_bf16 v[16:31], v[132:135], v[88:91], v[16:31]
    s_waitcnt lgkmcnt(4)
    ds_read_b128 v[80:83], v6 offset:11264
    v_mfma_f32_32x32x16_bf16 v[16:31], v[136:139], v[92:95], v[16:31]
    s_waitcnt lgkmcnt(3)
    ds_read_b128 v[84:87], v6 offset:12288
    v_mfma_f32_32x32x16_bf16 v[16:31], v[144:147], v[68:71], v[16:31]
    s_waitcnt lgkmcnt(3)
    v_mov_b32 v75, v100
    ds_read_b128 v[88:91], v6 offset:13312
    ds_read_b128 v[92:95], v6 offset:14336
    v_mfma_f32_32x32x16_bf16 v[16:31], v[148:151], v[72:75], v[16:31]
    s_waitcnt lgkmcnt(4)
    ds_read_b128 v[96:99], v6 offset:23552
    v_mfma_f32_32x32x16_bf16 v[16:31], v[152:155], v[76:79], v[16:31]
    s_waitcnt lgkmcnt(4)
    v_mov_b32 v83, v101
    ds_read_b128 v[68:71], v6 offset:16384
    s_nop 0
    v_mfma_f32_32x32x16_bf16 v[16:31], v[156:159], v[80:83], v[16:31]
    s_waitcnt lgkmcnt(4)
    ds_read_b128 v[72:75], v6 offset:17408
    v_mfma_f32_32x32x16_bf16 v[16:31], v[160:163], v[84:87], v[16:31]
    s_waitcnt lgkmcnt(4)
    v_mov_b32 v91, v102
    ds_read_b128 v[76:79], v6 offset:18432
    s_nop 0
    v_mfma_f32_32x32x16_bf16 v[16:31], v[164:167], v[88:91], v[16:31]
    s_waitcnt lgkmcnt(4)
    ds_read_b128 v[80:83], v6 offset:19456
    v_mfma_f32_32x32x16_bf16 v[16:31], v[168:171], v[92:95], v[16:31]
    s_waitcnt lgkmcnt(3)
    ds_read_b128 v[84:87], v6 offset:20480
    v_mfma_f32_32x32x16_bf16 v[16:31], v[176:179], v[68:71], v[16:31]
    s_waitcnt lgkmcnt(3)
    v_mov_b32 v75, v96
    ds_read_b128 v[88:91], v6 offset:21504
    ds_read_b128 v[92:95], v6 offset:22528
    v_mfma_f32_32x32x16_bf16 v[16:31], v[180:183], v[72:75], v[16:31]
    s_waitcnt lgkmcnt(4)
    ds_read_b128 v[100:103], v6 offset:31744
    v_mfma_f32_32x32x16_bf16 v[16:31], v[184:187], v[76:79], v[16:31]
    s_waitcnt lgkmcnt(4)
    v_mov_b32 v83, v97
    ds_read_b128 v[68:71], v6 offset:24576
    s_nop 0
    v_mfma_f32_32x32x16_bf16 v[16:31], v[188:191], v[80:83], v[16:31]
    s_waitcnt lgkmcnt(4)
    ds_read_b128 v[72:75], v6 offset:25600
    v_mfma_f32_32x32x16_bf16 v[16:31], v[192:195], v[84:87], v[16:31]
    s_waitcnt lgkmcnt(4)
    v_mov_b32 v91, v98
    ds_read_b128 v[76:79], v6 offset:26624
    s_nop 0
    v_mfma_f32_32x32x16_bf16 v[16:31], v[196:199], v[88:91], v[16:31]
    s_waitcnt lgkmcnt(4)
    ds_read_b128 v[80:83], v6 offset:27648
    v_mfma_f32_32x32x16_bf16 v[16:31], v[200:203], v[92:95], v[16:31]
    s_waitcnt lgkmcnt(3)
    ds_read_b128 v[84:87], v6 offset:28672
    v_mfma_f32_32x32x16_bf16 v[16:31], v[208:211], v[68:71], v[16:31]
    s_waitcnt lgkmcnt(3)
    v_mov_b32 v75, v100
    ds_read_b128 v[88:91], v6 offset:29696
    ds_read_b128 v[92:95], v6 offset:30720
    v_mfma_f32_32x32x16_bf16 v[16:31], v[212:215], v[72:75], v[16:31]
    s_waitcnt lgkmcnt(4)
    v_mfma_f32_32x32x16_bf16 v[16:31], v[216:219], v[76:79], v[16:31]
    s_waitcnt lgkmcnt(3)
    v_mov_b32 v83, v101
    s_nop 1
    v_mfma_f32_32x32x16_bf16 v[16:31], v[220:223], v[80:83], v[16:31]
    s_waitcnt lgkmcnt(2)
    v_mfma_f32_32x32x16_bf16 v[16:31], v[224:227], v[84:87], v[16:31]
    s_waitcnt lgkmcnt(1)
    v_mov_b32 v91, v102
    s_nop 1
    v_mfma_f32_32x32x16_bf16 v[16:31], v[228:231], v[88:91], v[16:31]
    s_waitcnt lgkmcnt(0)
    v_mfma_f32_32x32x16_bf16 v[16:31], v[232:235], v[92:95], v[16:31]
    s_nop 11
    v_cvt_pk_bf16_f32 v32, v16, v17
    v_cvt_pk_bf16_f32 v33, v18, v19
    v_cvt_pk_bf16_f32 v34, v20, v21
    v_cvt_pk_bf16_f32 v35, v22, v23
    ds_write_b128 v1, v[32:35]
    v_cvt_pk_bf16_f32 v36, v24, v25
    v_cvt_pk_bf16_f32 v37, v26, v27
    v_cvt_pk_bf16_f32 v38, v28, v29
    v_cvt_pk_bf16_f32 v39, v30, v31
    ds_write_b128 v2, v[36:39]
    ds_read_b128 v[40:43], v3
    ds_read_b128 v[44:47], v3 offset:1024
    s_waitcnt lgkmcnt(1)
    buffer_store_dwordx4 v[40:43], v4, s[32:35], s41 offen sc1
    s_waitcnt lgkmcnt(0)
    buffer_store_dwordx4 v[44:47], v4, s[32:35], s42 offen sc1
    s_branch L_end
L_fallback:
    v_mov_b32_dpp v46, v7 quad_perm:[0,1,2,3] row_mask:0xc bank_mask:0xf
    v_mov_b32 v12, 0xff800000
    s_mov_b32 s43, 2686976
fb1_101:
    buffer_load_dwordx4 v[176:179], v1, s[36:39], s43 offen sc1
    buffer_load_dwordx4 v[180:183], v2, s[36:39], s43 offen sc1
    s_waitcnt vmcnt(0)
    v_mfma_f32_32x32x16_bf16 v[48:63], v[176:179], v[40:43], 0
    v_mfma_f32_32x32x16_bf16 v[48:63], v[180:183], v[44:47], v[48:63]
    s_nop 11
    v_max3_f32 v12, v12, v48, v49
    v_max3_f32 v12, v12, v50, v51
    v_max3_f32 v12, v12, v52, v53
    v_max3_f32 v12, v12, v54, v55
    v_max3_f32 v12, v12, v56, v57
    v_max3_f32 v12, v12, v58, v59
    v_max3_f32 v12, v12, v60, v61
    v_max3_f32 v12, v12, v62, v63
    s_add_u32 s43, s43, 61440
    s_cmp_lt_u32 s43, 6619136
    s_cbranch_scc1 fb1_101
    v_mov_b32 v13, v12
    v_mov_b32 v14, v12
    s_nop 1
    v_permlane32_swap_b32 v13, v14
    v_max_f32 v12, v13, v14
    v_mov_b32 v160, 0
    v_mov_b32 v161, 0
    v_mov_b32 v162, 0
    v_mov_b32 v163, 0
    v_mov_b32 v164, 0
    v_mov_b32 v165, 0
    v_mov_b32 v166, 0
    v_mov_b32 v167, 0
    v_mov_b32 v168, 0
    v_mov_b32 v169, 0
    v_mov_b32 v170, 0
    v_mov_b32 v171, 0
    v_mov_b32 v172, 0
    v_mov_b32 v173, 0
    v_mov_b32 v174, 0
    v_mov_b32 v175, 0
    s_mov_b32 s43, 2686976
fb2_102:
    buffer_load_dwordx4 v[176:179], v1, s[36:39], s43 offen sc1
    buffer_load_dwordx4 v[180:183], v2, s[36:39], s43 offen sc1
    buffer_load_dwordx4 v[184:187], v3, s[36:39], s43 offen sc1
    buffer_load_dwordx4 v[188:191], v3, s[36:39], s43 offen offset:1024 sc1
    s_waitcnt vmcnt(0)
    v_mfma_f32_32x32x16_bf16 v[48:63], v[176:179], v[40:43], 0
    v_mfma_f32_32x32x16_bf16 v[48:63], v[180:183], v[44:47], v[48:63]
    s_nop 11
    v_sub_f32 v48, v48, v12
    v_sub_f32 v49, v49, v12
    v_sub_f32 v50, v50, v12
    v_sub_f32 v51, v51, v12
    v_sub_f32 v52, v52, v12
    v_sub_f32 v53, v53, v12
    v_sub_f32 v54, v54, v12
    v_sub_f32 v55, v55, v12
    v_sub_f32 v56, v56, v12
    v_sub_f32 v57, v57, v12
    v_sub_f32 v58, v58, v12
    v_sub_f32 v59, v59, v12
    v_sub_f32 v60, v60, v12
    v_sub_f32 v61, v61, v12
    v_sub_f32 v62, v62, v12
    v_sub_f32 v63, v63, v12
    v_exp_f32 v48, v48
    v_exp_f32 v49, v49
    v_exp_f32 v50, v50
    v_exp_f32 v51, v51
    v_exp_f32 v52, v52
    v_exp_f32 v53, v53
    v_exp_f32 v54, v54
    v_exp_f32 v55, v55
    v_exp_f32 v56, v56
    v_exp_f32 v57, v57
    v_exp_f32 v58, v58
    v_exp_f32 v59, v59
    v_exp_f32 v60, v60
    v_exp_f32 v61, v61
    v_exp_f32 v62, v62
    v_exp_f32 v63, v63
    v_smfmac_f32_32x32x32_bf16 v[160:175], v[184:187], v[48:55], v5
    s_nop 0
    v_smfmac_f32_32x32x32_bf16 v[160:175], v[188:191], v[56:63], v5
    s_nop 15
    s_add_u32 s43, s43, 61440
    s_cmp_lt_u32 s43, 6619136
    s_cbranch_scc1 fb2_102
    s_branch L_norm
L_end:
L_fin:
    s_endpgm
.section .rodata,"a"
.p2align 6
.amdhsa_kernel concat_heads__spectral_gfnet__softmax_full_mha__prompt_kernel
  .amdhsa_next_free_vgpr 256
  .amdhsa_next_free_sgpr 102
  .amdhsa_accum_offset 256
  .amdhsa_group_segment_fixed_size 0
  .amdhsa_kernarg_size 72
  .amdhsa_user_sgpr_count 2
  .amdhsa_user_sgpr_kernarg_segment_ptr 1
  .amdhsa_system_sgpr_workgroup_id_x 1
.end_amdhsa_kernel
```
